```python
import torch

def _softmax(x, axis=-1):
    return torch.softmax(x, dim=axis)

def _gelu(x):
    return torch.nn.functional.gelu(x, approximate='tanh')

def _silu(x):
    return torch.nn.functional.silu(x)

def _sigmoid(x):
    return torch.sigmoid(x)

def _layernorm(x, axis=-1, eps=1e-05):
    m = x.mean(dim=axis, keepdim=True)
    v = x.var(dim=axis, keepdim=True, unbiased=False)
    return (x - m) / torch.sqrt(v + eps)

def _scatter_add(tgt, idx, src, axis=0):
    return tgt.clone().index_add_(axis, idx, src)

def _segment_sum(src, seg, n):
    out = torch.zeros((n,) + src.shape[1:], dtype=src.dtype)
    return out.index_add_(0, seg, src)

def _pad(x, pw):
    flat = tuple((v for pair in reversed(pw) for v in pair))
    return torch.nn.functional.pad(x, flat)
kernel_name = 'adaLN_cond__ssm_conv_h3__dense_activation_squared_relu__prompt'

def setup_inputs():

    _w = lambda a: (lambda t: t.to(torch.bfloat16) if t.is_floating_point() else t)(torch.as_tensor(a))

    def _A_setup():
        B, S, D = (1, 2048, 512)
        ks = 4
        return {'q': _w((lambda *s: torch.randn(*s, dtype=torch.bfloat16) * 0.05)(B, S, D)), 'k': _w((lambda *s: torch.randn(*s, dtype=torch.bfloat16) * 0.8)(B, S, D)), 'v': _w((lambda *s: torch.randn(*s, dtype=torch.bfloat16) * 0.8)(B, S, D)), 'shift_k': _w((lambda *s: torch.randn(*s, dtype=torch.bfloat16) * 0.8)(D, ks) * 0.5), 'ssm_k': _w((lambda *s: torch.randn(*s, dtype=torch.bfloat16) * 0.8)(D, S) * (1.0 / S ** 0.5)), 'ssm_D': _w((lambda *s: torch.randn(*s, dtype=torch.bfloat16) * 0.8)(D))}
    _A_in = _A_setup()

    def _B_setup():
        B, S, D, F = (1, 2048, 512, 1376)
        return {'x': _w((lambda *s: torch.randn(*s, dtype=torch.bfloat16) * 0.05)(B, S, D)), 'w1': _w((lambda *s: torch.randn(*s, dtype=torch.bfloat16) * 0.05)(D, F)), 'b1': _w((lambda *s: torch.randn(*s, dtype=torch.bfloat16) * 0.4)(F)), 'w2': _w((lambda *s: torch.randn(*s, dtype=torch.bfloat16) * 0.05)(F, D)), 'b2': _w((lambda *s: torch.randn(*s, dtype=torch.bfloat16) * 3.2)(D))}
    _B_in = _B_setup()
    return {'A_q': _A_in['q'], 'A_k': _A_in['k'], 'A_v': _A_in['v'], 'A_shift_k': _A_in['shift_k'], 'A_ssm_k': _A_in['ssm_k'], 'A_ssm_D': _A_in['ssm_D'], 'B_x': _B_in['x'], 'B_w1': _B_in['w1'], 'B_b1': _B_in['b1'], 'B_w2': _B_in['w2'], 'B_b2': _B_in['b2'], 'c': _w((lambda *s: torch.randn(*s, dtype=torch.bfloat16) * 0.1)(1, 512) * 8.0), 'w_mod': _w((lambda *s: torch.randn(*s, dtype=torch.bfloat16) * 0.1)(512, 6 * 512) * 512 ** (-0.5) * 8.0)}

def reference(A_q, A_k, A_v, A_shift_k, A_ssm_k, A_ssm_D, B_x, B_w1, B_b1, B_w2, B_b2, c, w_mod):

    def _A_ref(q, k, v, shift_k, ssm_k, ssm_D):
        B, S, D = q.shape
        ks = shift_k.shape[-1]
        k_pad = _pad(k, ((0, 0), (ks - 1, 0), (0, 0)))
        k_shift = torch.zeros_like(k)
        for t in range(ks):
            k_shift = k_shift + k_pad[:, t:t + S, :] * shift_k[:, ks - 1 - t][None, None, :]
        kv = k_shift * v
        L = 2 * S
        kv_pad = _pad(kv, ((0, 0), (0, S), (0, 0)))
        kf_pad = _pad(ssm_k, ((0, 0), (0, S)))
        kv_f = (lambda x, axes=(-2, -1): torch.fft.rfft2(x.float(), dim=axes))(kv_pad[:, None, :, :], axes=(1, 2))
        kf_f = (lambda x, axes=(-2, -1): torch.fft.rfft2(x.float(), dim=axes))(kf_pad[:, None, :], axes=(1, 2))
        kf_f = (lambda x, *d: x.permute(*d))(kf_f, 1, 2, 0)
        y_f = kv_f * kf_f[None, :, :, :]
        y = (lambda x, s, axes=(-2, -1): torch.fft.irfft2(x, s=s, dim=axes).to(torch.bfloat16))(y_f, (1, L), axes=(1, 2))[:, 0, :S, :]
        y = y + kv * ssm_D[None, None, :]
        return q * y

    def _B_ref(x, w1, b1, w2, b2):
        h = torch.einsum('bsd,df->bsf', x, w1) + b1
        zero = torch.zeros_like(h)
        r = torch.where(h > zero, h, zero)
        h = r * r
        out = torch.einsum('bsf,fd->bsd', h, w2) + b2
        return out
    x = A_q
    mod = (_silu(c) @ w_mod).reshape(c.shape[0], 6, 1, -1)
    sa, ca, ga, sb, cb, gb = (mod[:, 0].clone(), mod[:, 1].clone(), mod[:, 2].clone(), mod[:, 3].clone(), mod[:, 4].clone(), mod[:, 5].clone())
    h = _layernorm(x, axis=-1) * (1 + ca) + sa
    x = x + ga * _A_ref(h, A_k, A_v, A_shift_k, A_ssm_k, A_ssm_D)
    h = _layernorm(x, axis=-1) * (1 + cb) + sb
    x = x + gb * _B_ref(h, B_w1, B_b1, B_w2, B_b2)
    return x
```

```asm
; @launch grid=(256,1,1) block=(256,1,1) lds=143872
.amdgcn_target "amdgcn-amd-amdhsa--gfx950"
.text
.globl adaLN_cond__ssm_conv_h3__dense_activation_squared_relu__prompt_kernel
.p2align 8
.type adaLN_cond__ssm_conv_h3__dense_activation_squared_relu__prompt_kernel,@function
adaLN_cond__ssm_conv_h3__dense_activation_squared_relu__prompt_kernel:
    s_load_dwordx16 s[8:23], s[0:1], 0
    s_load_dwordx16 s[24:39], s[0:1], 64
    v_lshrrev_b32 v1, 6, v0
    s_nop 0
    v_readfirstlane_b32 s4, v1
    s_mov_b32 s5, 0xffff0000
    s_cmp_ge_u32 s2, 256
    s_nop 2
    s_cbranch_scc1 MEGA_END
    v_and_b32 v2, 63, v0
    v_lshrrev_b32 v3, 4, v2
    v_bfe_u32 v4, v0, 2, 2
    v_and_b32 v5, 3, v0
    v_lshlrev_b32 v6, 4, v2
    v_and_b32 v7, 7, v0
    v_lshrrev_b32 v8, 3, v2
    s_getpc_b64 s[6:7]
    s_lshr_b32 s3, s2, 3
    s_and_b32 s3, s3, 7
    s_lshl_b32 s3, s3, 2
    s_add_u32 s3, s3, s4
    s_lshl_b32 s3, s3, 10
    s_min_u32 s3, s3, 23264
    v_add_u32 v9, s3, v6
    global_load_dwordx4 v[252:255], v9, s[6:7]
    s_lshr_b32 s62, s2, 2
    s_and_b32 s63, s2, 3
    s_lshr_b32 s66, s2, 3
    s_and_b32 s67, s2, 7
    s_and_b32 s72, s2, 31
    s_lshr_b32 s73, s2, 5
    s_lshl_b32 s74, s72, 3
    s_add_u32 s74, s74, s73
    s_lshl_b32 s68, s66, 16
    s_lshl_b32 s69, s67, 7
    s_add_u32 s68, s68, s69
    s_sub_u32 s68, s68, 3072
    v_lshrrev_b32 v12, 3, v0
    v_lshlrev_b32 v13, 11, v12
    v_lshl_add_u32 v13, v7, 4, v13
    v_add_u32 v13, s68, v13
    v_add_u32 v14, 0x400, v13
    v_add_u32 v15, 0x800, v13
    v_add_u32 v16, 0xc00, v13
    v_lshlrev_b32 v17, 6, v7
    s_lshr_b32 s68, s74, 1
    s_and_b32 s69, s74, 1
    s_lshl_b32 s69, s69, 3
    s_and_b32 s3, s4, 1
    s_lshl_b32 s3, s3, 2
    s_add_u32 s69, s69, s3
    s_lshl_b32 s69, s69, 7
    s_add_u32 s69, s69, s68
    s_lshl_b32 s69, s69, 10
    s_lshl_b32 s68, s67, 9
    v_mul_u32_u24 v18, 288, v12
    v_lshl_add_u32 v18, v7, 4, v18
    v_mov_b32 v56, 0
    s_and_b32 s82, s4, 1
    s_waitcnt lgkmcnt(0)
    s_mov_b32 s44, s10
    s_mov_b32 s45, s11
    s_mov_b32 s46, 2097152
    s_mov_b32 s47, 0x20000
    s_mov_b32 s48, s12
    s_mov_b32 s49, s13
    s_mov_b32 s50, 2097152
    s_mov_b32 s51, 0x20000
    s_mov_b32 s52, s14
    s_mov_b32 s53, s15
    s_mov_b32 s54, 4096
    s_mov_b32 s55, 0x20000
    s_mov_b32 s56, s8
    s_mov_b32 s57, s9
    s_mov_b32 s58, 2097152
    s_mov_b32 s59, 0x20000
    s_mov_b32 s40, s38
    s_mov_b32 s41, s39
    s_mov_b32 s42, 23068672
    s_mov_b32 s43, 0x20000
    s_cmp_ge_u32 s4, 2
    s_nop 0
    s_cbranch_scc1 PATH_Y
    s_or_b32 s3, s2, s4
    s_cmp_lg_u32 s3, 0
    s_nop 0
    s_cbranch_scc1 NONCE_SKIP
    s_mov_b32 s76, s36
    s_mov_b32 s77, s37
    s_mov_b32 s78, 256
    s_mov_b32 s79, 0x20000
    s_memrealtime s[60:61]
    s_waitcnt lgkmcnt(0)
    s_or_b32 s60, s60, 1
    v_mov_b32 v20, s60
    v_mov_b32 v21, s61
    s_mov_b64 exec, 1
    buffer_store_dwordx2 v[20:21], v56, s[76:79], 0 offen sc1
    s_mov_b64 exec, -1
    s_nop 1
NONCE_SKIP:
    buffer_load_dwordx4 v[140:143], v16, s[44:47], 0 offen nt
    buffer_load_dwordx4 v[144:147], v16, s[44:47], 0 offen offset:1024 nt
    buffer_load_dwordx4 v[148:151], v16, s[48:51], 0 offen nt
    buffer_load_dwordx4 v[152:155], v16, s[48:51], 0 offen offset:1024 nt
    buffer_load_dwordx4 v[156:159], v17, s[52:55], s68 offen offset:0 nt
    buffer_load_dwordx4 v[160:163], v17, s[52:55], s68 offen offset:16 nt
    buffer_load_dwordx4 v[164:167], v17, s[52:55], s68 offen offset:32 nt
    buffer_load_dwordx4 v[168:171], v17, s[52:55], s68 offen offset:48 nt
    buffer_load_dwordx4 v[128:131], v13, s[44:47], 0 offen nt
    buffer_load_dwordx4 v[132:135], v14, s[44:47], 0 offen nt
    buffer_load_dwordx4 v[136:139], v15, s[44:47], 0 offen nt
    v_lshlrev_b32 v100, 17, v8
    v_lshl_add_u32 v100, v7, 4, v100
    s_lshl_b32 s64, s72, 2
    s_lshl_b32 s3, s82, 1
    s_add_u32 s64, s64, s3
    s_lshl_b32 s64, s64, 10
    s_lshl_b32 s65, s73, 7
    s_add_u32 s64, s64, s65
    s_lshl_b32 s65, s82, 12
    s_add_u32 s65, s65, 43520
    s_mov_b32 m0, s65
    s_nop 0
    buffer_load_dwordx4 v100, s[56:59], s64 offen nt lds
    s_add_u32 s64, s64, 0x100000
    s_add_u32 s65, s65, 1024
    s_mov_b32 m0, s65
    s_nop 0
    buffer_load_dwordx4 v100, s[56:59], s64 offen nt lds
    s_sub_u32 s64, s64, 0xffc00
    s_add_u32 s65, s65, 1024
    s_mov_b32 m0, s65
    s_nop 0
    buffer_load_dwordx4 v100, s[56:59], s64 offen nt lds
    s_add_u32 s64, s64, 0x100000
    s_add_u32 s65, s65, 1024
    s_mov_b32 m0, s65
    s_nop 0
    buffer_load_dwordx4 v100, s[56:59], s64 offen nt lds
    buffer_load_dwordx4 v[172:175], v6, s[56:59], s69 offen nt
    s_add_u32 s69, s69, 0x20000
    buffer_load_dwordx4 v[176:179], v6, s[56:59], s69 offen nt
    s_add_u32 s69, s69, 0x20000
    buffer_load_dwordx4 v[180:183], v6, s[56:59], s69 offen nt
    s_add_u32 s69, s69, 0x20000
    buffer_load_dwordx4 v[184:187], v6, s[56:59], s69 offen nt
    s_mov_b32 s48, s30
    s_mov_b32 s49, s31
    s_mov_b32 s50, 1024
    s_mov_b32 s51, 0x20000
    v_lshlrev_b32 v10, 2, v2
    s_lshl_b32 s64, s63, 8
    buffer_load_dword v11, v10, s[48:51], s64 offen nt
    s_mov_b32 s44, s16
    s_mov_b32 s45, s17
    s_mov_b32 s46, 2097152
    s_mov_b32 s47, 0x20000
    s_lshl_b32 s64, s2, 13
    s_lshr_b32 s65, s4, 1
    s_lshl_b32 s65, s65, 12
    s_add_u32 s64, s64, s65
    s_mul_i32 s65, s4, 4160
    s_add_u32 s65, s65, 85568
    s_mov_b32 m0, s65
    s_nop 0
    buffer_load_dwordx4 v6, s[44:47], s64 offen nt lds
    buffer_load_dwordx4 v6, s[44:47], s64 offen offset:1024 nt lds
    buffer_load_dwordx4 v6, s[44:47], s64 offen offset:2048 nt lds
    buffer_load_dwordx4 v6, s[44:47], s64 offen offset:3072 nt lds
    s_mov_b32 s56, s36
    s_mov_b32 s57, s37
    s_mov_b32 s58, 256
    s_mov_b32 s59, 0x20000
    s_lshl_b32 s3, s2, 2
    s_add_u32 s6, s18, s3
    s_addc_u32 s7, s19, 0
    s_load_dword s81, s[6:7], 0
    v_lshl_add_u32 v13, v4, 2, v3
    v_mul_u32_u24 v13, 144, v13
    v_lshl_add_u32 v13, v5, 3, v13
    s_lshl_b32 s64, s82, 6
    v_add_u32 v13, s64, v13
    v_lshl_add_u32 v14, v3, 3, v4
    v_lshlrev_b32 v14, 7, v14
    v_lshl_add_u32 v14, v5, 3, v14
    v_add_u32 v14, s64, v14
    v_bfe_u32 v15, v0, 1, 3
    v_mul_u32_u24 v15, 8448, v15
    v_and_b32 v16, 1, v0
    v_lshl_add_u32 v15, v16, 6, v15
    v_lshl_add_u32 v16, v3, 4, v15
    s_mul_i32 s65, s82, 135168
    s_mul_i32 s75, s67, 270336
    s_add_u32 s75, s75, s65
    s_lshl_b32 s3, s66, 8
    s_add_u32 s75, s75, s3
    s_mul_i32 s69, s73, 270336
    s_add_u32 s69, s69, s65
    s_lshl_b32 s3, s72, 8
    s_add_u32 s69, s69, s3
    s_add_u32 s69, s69, 2621440
    s_add_u32 s64, s75, 67584
    s_add_u32 s65, s69, 67584
    s_waitcnt vmcnt(19)
    v_lshlrev_b32 v74, 16, v156
    v_lshlrev_b32 v75, 16, v158
    v_and_b32 v76, s5, v156
    v_and_b32 v77, s5, v158
    v_lshlrev_b32 v78, 16, v157
    v_lshlrev_b32 v79, 16, v159
    v_and_b32 v80, s5, v157
    v_and_b32 v81, s5, v159
    s_waitcnt vmcnt(15)
    v_lshlrev_b32 v60, 16, v128
    v_and_b32 v61, s5, v128
    s_waitcnt vmcnt(14)
    v_lshlrev_b32 v62, 16, v132
    v_and_b32 v63, s5, v132
    s_waitcnt vmcnt(13)
    v_lshlrev_b32 v64, 16, v136
    v_and_b32 v65, s5, v136
    v_lshlrev_b32 v66, 16, v140
    v_and_b32 v67, s5, v140
    v_lshlrev_b32 v68, 16, v144
    v_and_b32 v69, s5, v144
    v_pk_mul_f32 v[82:83], v[60:61], v[80:81]
    v_pk_mul_f32 v[84:85], v[62:63], v[80:81]
    v_pk_fma_f32 v[82:83], v[62:63], v[78:79], v[82:83]
    v_pk_fma_f32 v[84:85], v[64:65], v[78:79], v[84:85]
    v_pk_fma_f32 v[82:83], v[64:65], v[76:77], v[82:83]
    v_pk_fma_f32 v[84:85], v[66:67], v[76:77], v[84:85]
    v_pk_fma_f32 v[82:83], v[66:67], v[74:75], v[82:83]
    v_pk_fma_f32 v[84:85], v[68:69], v[74:75], v[84:85]
    v_lshlrev_b32 v70, 16, v148
    v_and_b32 v71, s5, v148
    v_lshlrev_b32 v72, 16, v152
    v_and_b32 v73, s5, v152
    v_cvt_pk_bf16_f32 v82, 0, v82
    v_cvt_pk_bf16_f32 v83, 0, v83
    v_cvt_pk_bf16_f32 v84, 0, v84
    v_cvt_pk_bf16_f32 v85, 0, v85
    v_pk_mul_f32 v[82:83], v[82:83], v[70:71]
    v_pk_mul_f32 v[84:85], v[84:85], v[72:73]
    v_cvt_pk_bf16_f32 v92, v82, v83
    v_cvt_pk_bf16_f32 v96, v84, v85
    v_lshlrev_b32 v74, 16, v160
    v_lshlrev_b32 v75, 16, v162
    v_and_b32 v76, s5, v160
    v_and_b32 v77, s5, v162
    v_lshlrev_b32 v78, 16, v161
    v_lshlrev_b32 v79, 16, v163
    v_and_b32 v80, s5, v161
    v_and_b32 v81, s5, v163
    v_lshlrev_b32 v60, 16, v129
    v_and_b32 v61, s5, v129
    v_lshlrev_b32 v62, 16, v133
    v_and_b32 v63, s5, v133
    v_lshlrev_b32 v64, 16, v137
    v_and_b32 v65, s5, v137
    v_lshlrev_b32 v66, 16, v141
    v_and_b32 v67, s5, v141
    v_lshlrev_b32 v68, 16, v145
    v_and_b32 v69, s5, v145
    v_pk_mul_f32 v[82:83], v[60:61], v[80:81]
    v_pk_mul_f32 v[84:85], v[62:63], v[80:81]
    v_pk_fma_f32 v[82:83], v[62:63], v[78:79], v[82:83]
    v_pk_fma_f32 v[84:85], v[64:65], v[78:79], v[84:85]
    v_pk_fma_f32 v[82:83], v[64:65], v[76:77], v[82:83]
    v_pk_fma_f32 v[84:85], v[66:67], v[76:77], v[84:85]
    v_pk_fma_f32 v[82:83], v[66:67], v[74:75], v[82:83]
    v_pk_fma_f32 v[84:85], v[68:69], v[74:75], v[84:85]
    v_lshlrev_b32 v70, 16, v149
    v_and_b32 v71, s5, v149
    v_lshlrev_b32 v72, 16, v153
    v_and_b32 v73, s5, v153
    v_cvt_pk_bf16_f32 v82, 0, v82
    v_cvt_pk_bf16_f32 v83, 0, v83
    v_cvt_pk_bf16_f32 v84, 0, v84
    v_cvt_pk_bf16_f32 v85, 0, v85
    v_pk_mul_f32 v[82:83], v[82:83], v[70:71]
    v_pk_mul_f32 v[84:85], v[84:85], v[72:73]
    v_cvt_pk_bf16_f32 v93, v82, v83
    v_cvt_pk_bf16_f32 v97, v84, v85
    v_lshlrev_b32 v74, 16, v164
    v_lshlrev_b32 v75, 16, v166
    v_and_b32 v76, s5, v164
    v_and_b32 v77, s5, v166
    v_lshlrev_b32 v78, 16, v165
    v_lshlrev_b32 v79, 16, v167
    v_and_b32 v80, s5, v165
    v_and_b32 v81, s5, v167
    v_lshlrev_b32 v60, 16, v130
    v_and_b32 v61, s5, v130
    v_lshlrev_b32 v62, 16, v134
    v_and_b32 v63, s5, v134
    v_lshlrev_b32 v64, 16, v138
    v_and_b32 v65, s5, v138
    v_lshlrev_b32 v66, 16, v142
    v_and_b32 v67, s5, v142
    v_lshlrev_b32 v68, 16, v146
    v_and_b32 v69, s5, v146
    v_pk_mul_f32 v[82:83], v[60:61], v[80:81]
    v_pk_mul_f32 v[84:85], v[62:63], v[80:81]
    v_pk_fma_f32 v[82:83], v[62:63], v[78:79], v[82:83]
    v_pk_fma_f32 v[84:85], v[64:65], v[78:79], v[84:85]
    v_pk_fma_f32 v[82:83], v[64:65], v[76:77], v[82:83]
    v_pk_fma_f32 v[84:85], v[66:67], v[76:77], v[84:85]
    v_pk_fma_f32 v[82:83], v[66:67], v[74:75], v[82:83]
    v_pk_fma_f32 v[84:85], v[68:69], v[74:75], v[84:85]
    v_lshlrev_b32 v70, 16, v150
    v_and_b32 v71, s5, v150
    v_lshlrev_b32 v72, 16, v154
    v_and_b32 v73, s5, v154
    v_cvt_pk_bf16_f32 v82, 0, v82
    v_cvt_pk_bf16_f32 v83, 0, v83
    v_cvt_pk_bf16_f32 v84, 0, v84
    v_cvt_pk_bf16_f32 v85, 0, v85
    v_pk_mul_f32 v[82:83], v[82:83], v[70:71]
    v_pk_mul_f32 v[84:85], v[84:85], v[72:73]
    v_cvt_pk_bf16_f32 v94, v82, v83
    v_cvt_pk_bf16_f32 v98, v84, v85
    v_lshlrev_b32 v74, 16, v168
    v_lshlrev_b32 v75, 16, v170
    v_and_b32 v76, s5, v168
    v_and_b32 v77, s5, v170
    v_lshlrev_b32 v78, 16, v169
    v_lshlrev_b32 v79, 16, v171
    v_and_b32 v80, s5, v169
    v_and_b32 v81, s5, v171
    v_lshlrev_b32 v60, 16, v131
    v_and_b32 v61, s5, v131
    v_lshlrev_b32 v62, 16, v135
    v_and_b32 v63, s5, v135
    v_lshlrev_b32 v64, 16, v139
    v_and_b32 v65, s5, v139
    v_lshlrev_b32 v66, 16, v143
    v_and_b32 v67, s5, v143
    v_lshlrev_b32 v68, 16, v147
    v_and_b32 v69, s5, v147
    v_pk_mul_f32 v[82:83], v[60:61], v[80:81]
    v_pk_mul_f32 v[84:85], v[62:63], v[80:81]
    v_pk_fma_f32 v[82:83], v[62:63], v[78:79], v[82:83]
    v_pk_fma_f32 v[84:85], v[64:65], v[78:79], v[84:85]
    v_pk_fma_f32 v[82:83], v[64:65], v[76:77], v[82:83]
    v_pk_fma_f32 v[84:85], v[66:67], v[76:77], v[84:85]
    v_pk_fma_f32 v[82:83], v[66:67], v[74:75], v[82:83]
    v_pk_fma_f32 v[84:85], v[68:69], v[74:75], v[84:85]
    v_lshlrev_b32 v70, 16, v151
    v_and_b32 v71, s5, v151
    v_lshlrev_b32 v72, 16, v155
    v_and_b32 v73, s5, v155
    v_cvt_pk_bf16_f32 v82, 0, v82
    v_cvt_pk_bf16_f32 v83, 0, v83
    v_cvt_pk_bf16_f32 v84, 0, v84
    v_cvt_pk_bf16_f32 v85, 0, v85
    v_pk_mul_f32 v[82:83], v[82:83], v[70:71]
    v_pk_mul_f32 v[84:85], v[84:85], v[72:73]
    v_cvt_pk_bf16_f32 v95, v82, v83
    v_cvt_pk_bf16_f32 v99, v84, v85
    ds_write_b128 v18, v[92:95] offset:34304
    ds_write_b128 v18, v[96:99] offset:34448
    buffer_load_dwordx2 v[58:59], v56, s[56:59], 0 offen sc1
    s_waitcnt lgkmcnt(0)
    s_barrier
    ds_read_b64_tr_b16 v[20:21], v13 offset:34304
    ds_read_b64_tr_b16 v[22:23], v13 offset:36608
    ds_read_b64_tr_b16 v[24:25], v13 offset:38912
    ds_read_b64_tr_b16 v[26:27], v13 offset:41216
    ds_read_b64_tr_b16 v[28:29], v13 offset:34336
    ds_read_b64_tr_b16 v[30:31], v13 offset:36640
    ds_read_b64_tr_b16 v[32:33], v13 offset:38944
    ds_read_b64_tr_b16 v[34:35], v13 offset:41248
    v_mov_b32 v212, v14
    v_mov_b32 v213, v16
    s_mov_b32 s78, s69
    s_mov_b32 s79, s65
    s_waitcnt lgkmcnt(6)
    buffer_store_dwordx4 v[20:23], v16, s[40:43], s75 offen offset:0 sc1
    s_waitcnt lgkmcnt(4)
    buffer_store_dwordx4 v[24:27], v16, s[40:43], s75 offen offset:128 sc1
    s_waitcnt lgkmcnt(2)
    buffer_store_dwordx4 v[28:31], v16, s[40:43], s64 offen offset:0 sc1
    s_waitcnt lgkmcnt(0)
    buffer_store_dwordx4 v[32:35], v16, s[40:43], s64 offen offset:128 sc1
    s_waitcnt vmcnt(13)
    v_lshlrev_b32 v96, 16, v172
    v_and_b32 v97, s5, v172
    v_lshlrev_b32 v98, 16, v173
    v_and_b32 v99, s5, v173
    v_lshlrev_b32 v100, 16, v174
    v_and_b32 v101, s5, v174
    v_lshlrev_b32 v102, 16, v175
    v_and_b32 v103, s5, v175
    s_waitcnt vmcnt(12)
    v_lshlrev_b32 v104, 16, v176
    v_and_b32 v105, s5, v176
    v_lshlrev_b32 v106, 16, v177
    v_and_b32 v107, s5, v177
    v_lshlrev_b32 v108, 16, v178
    v_and_b32 v109, s5, v178
    v_lshlrev_b32 v110, 16, v179
    v_and_b32 v111, s5, v179
    s_waitcnt vmcnt(11)
    v_lshlrev_b32 v112, 16, v180
    v_and_b32 v113, s5, v180
    v_lshlrev_b32 v114, 16, v181
    v_and_b32 v115, s5, v181
    v_lshlrev_b32 v116, 16, v182
    v_and_b32 v117, s5, v182
    v_lshlrev_b32 v118, 16, v183
    v_and_b32 v119, s5, v183
    s_waitcnt vmcnt(10)
    v_lshlrev_b32 v120, 16, v184
    v_and_b32 v121, s5, v184
    v_lshlrev_b32 v122, 16, v185
    v_and_b32 v123, s5, v185
    v_lshlrev_b32 v124, 16, v186
    v_and_b32 v125, s5, v186
    v_lshlrev_b32 v126, 16, v187
    v_and_b32 v127, s5, v187
    v_pk_add_f32 v[60:61], v[96:97], v[98:99]
    v_pk_add_f32 v[62:63], v[100:101], v[102:103]
    v_pk_add_f32 v[60:61], v[60:61], v[62:63]
    v_add_f32 v60, v60, v61
    v_pk_add_f32 v[64:65], v[104:105], v[106:107]
    v_pk_add_f32 v[66:67], v[108:109], v[110:111]
    v_pk_add_f32 v[64:65], v[64:65], v[66:67]
    v_add_f32 v64, v64, v65
    v_pk_add_f32 v[68:69], v[112:113], v[114:115]
    v_pk_add_f32 v[70:71], v[116:117], v[118:119]
    v_pk_add_f32 v[68:69], v[68:69], v[70:71]
    v_add_f32 v68, v68, v69
    v_pk_add_f32 v[72:73], v[120:121], v[122:123]
    v_pk_add_f32 v[74:75], v[124:125], v[126:127]
    v_pk_add_f32 v[72:73], v[72:73], v[74:75]
    v_add_f32 v72, v72, v73
    v_add_f32_dpp v60, v60, v60 row_shr:1 row_mask:0xf bank_mask:0xf
    v_add_f32_dpp v64, v64, v64 row_shr:1 row_mask:0xf bank_mask:0xf
    v_add_f32_dpp v68, v68, v68 row_shr:1 row_mask:0xf bank_mask:0xf
    v_add_f32_dpp v72, v72, v72 row_shr:1 row_mask:0xf bank_mask:0xf
    v_add_f32_dpp v60, v60, v60 row_shr:2 row_mask:0xf bank_mask:0xf
    v_add_f32_dpp v64, v64, v64 row_shr:2 row_mask:0xf bank_mask:0xf
    v_add_f32_dpp v68, v68, v68 row_shr:2 row_mask:0xf bank_mask:0xf
    v_add_f32_dpp v72, v72, v72 row_shr:2 row_mask:0xf bank_mask:0xf
    v_add_f32_dpp v60, v60, v60 row_shr:4 row_mask:0xf bank_mask:0xf
    v_add_f32_dpp v64, v64, v64 row_shr:4 row_mask:0xf bank_mask:0xf
    v_add_f32_dpp v68, v68, v68 row_shr:4 row_mask:0xf bank_mask:0xf
    v_add_f32_dpp v72, v72, v72 row_shr:4 row_mask:0xf bank_mask:0xf
    v_add_f32_dpp v60, v60, v60 row_shr:8 row_mask:0xf bank_mask:0xf
    v_add_f32_dpp v64, v64, v64 row_shr:8 row_mask:0xf bank_mask:0xf
    v_add_f32_dpp v68, v68, v68 row_shr:8 row_mask:0xf bank_mask:0xf
    v_add_f32_dpp v72, v72, v72 row_shr:8 row_mask:0xf bank_mask:0xf
    v_add_f32_dpp v60, v60, v60 row_bcast:15 row_mask:0xa bank_mask:0xf
    v_add_f32_dpp v64, v64, v64 row_bcast:15 row_mask:0xa bank_mask:0xf
    v_add_f32_dpp v68, v68, v68 row_bcast:15 row_mask:0xa bank_mask:0xf
    v_add_f32_dpp v72, v72, v72 row_bcast:15 row_mask:0xa bank_mask:0xf
    v_add_f32_dpp v60, v60, v60 row_bcast:31 row_mask:0xc bank_mask:0xf
    v_add_f32_dpp v64, v64, v64 row_bcast:31 row_mask:0xc bank_mask:0xf
    v_add_f32_dpp v68, v68, v68 row_bcast:31 row_mask:0xc bank_mask:0xf
    v_add_f32_dpp v72, v72, v72 row_bcast:31 row_mask:0xc bank_mask:0xf
    v_readlane_b32 s70, v60, 63
    v_readlane_b32 s71, v64, 63
    v_readlane_b32 s64, v68, 63
    v_readlane_b32 s65, v72, 63
    s_mov_b32 s3, 0x3b000000
    v_mov_b32 v84, s70
    v_mul_f32 v84, s3, v84
    v_mov_b32 v85, s71
    v_mul_f32 v85, s3, v85
    v_mov_b32 v86, s64
    v_mul_f32 v86, s3, v86
    v_mov_b32 v87, s65
    v_mul_f32 v87, s3, v87
    v_pk_add_f32 v[96:97], v[96:97], v[84:85] op_sel:[0,0] op_sel_hi:[1,0] neg_lo:[0,1] neg_hi:[0,1]
    v_pk_add_f32 v[98:99], v[98:99], v[84:85] op_sel:[0,0] op_sel_hi:[1,0] neg_lo:[0,1] neg_hi:[0,1]
    v_pk_add_f32 v[100:101], v[100:101], v[84:85] op_sel:[0,0] op_sel_hi:[1,0] neg_lo:[0,1] neg_hi:[0,1]
    v_pk_add_f32 v[102:103], v[102:103], v[84:85] op_sel:[0,0] op_sel_hi:[1,0] neg_lo:[0,1] neg_hi:[0,1]
    v_pk_mul_f32 v[60:61], v[96:97], v[96:97]
    v_pk_fma_f32 v[60:61], v[98:99], v[98:99], v[60:61]
    v_pk_fma_f32 v[60:61], v[100:101], v[100:101], v[60:61]
    v_pk_fma_f32 v[60:61], v[102:103], v[102:103], v[60:61]
    v_add_f32 v60, v60, v61
    v_pk_add_f32 v[104:105], v[104:105], v[84:85] op_sel:[0,1] op_sel_hi:[1,1] neg_lo:[0,1] neg_hi:[0,1]
    v_pk_add_f32 v[106:107], v[106:107], v[84:85] op_sel:[0,1] op_sel_hi:[1,1] neg_lo:[0,1] neg_hi:[0,1]
    v_pk_add_f32 v[108:109], v[108:109], v[84:85] op_sel:[0,1] op_sel_hi:[1,1] neg_lo:[0,1] neg_hi:[0,1]
    v_pk_add_f32 v[110:111], v[110:111], v[84:85] op_sel:[0,1] op_sel_hi:[1,1] neg_lo:[0,1] neg_hi:[0,1]
    v_pk_mul_f32 v[64:65], v[104:105], v[104:105]
    v_pk_fma_f32 v[64:65], v[106:107], v[106:107], v[64:65]
    v_pk_fma_f32 v[64:65], v[108:109], v[108:109], v[64:65]
    v_pk_fma_f32 v[64:65], v[110:111], v[110:111], v[64:65]
    v_add_f32 v64, v64, v65
    v_pk_add_f32 v[112:113], v[112:113], v[86:87] op_sel:[0,0] op_sel_hi:[1,0] neg_lo:[0,1] neg_hi:[0,1]
    v_pk_add_f32 v[114:115], v[114:115], v[86:87] op_sel:[0,0] op_sel_hi:[1,0] neg_lo:[0,1] neg_hi:[0,1]
    v_pk_add_f32 v[116:117], v[116:117], v[86:87] op_sel:[0,0] op_sel_hi:[1,0] neg_lo:[0,1] neg_hi:[0,1]
    v_pk_add_f32 v[118:119], v[118:119], v[86:87] op_sel:[0,0] op_sel_hi:[1,0] neg_lo:[0,1] neg_hi:[0,1]
    v_pk_mul_f32 v[68:69], v[112:113], v[112:113]
    v_pk_fma_f32 v[68:69], v[114:115], v[114:115], v[68:69]
    v_pk_fma_f32 v[68:69], v[116:117], v[116:117], v[68:69]
    v_pk_fma_f32 v[68:69], v[118:119], v[118:119], v[68:69]
    v_add_f32 v68, v68, v69
    v_pk_add_f32 v[120:121], v[120:121], v[86:87] op_sel:[0,1] op_sel_hi:[1,1] neg_lo:[0,1] neg_hi:[0,1]
    v_pk_add_f32 v[122:123], v[122:123], v[86:87] op_sel:[0,1] op_sel_hi:[1,1] neg_lo:[0,1] neg_hi:[0,1]
    v_pk_add_f32 v[124:125], v[124:125], v[86:87] op_sel:[0,1] op_sel_hi:[1,1] neg_lo:[0,1] neg_hi:[0,1]
    v_pk_add_f32 v[126:127], v[126:127], v[86:87] op_sel:[0,1] op_sel_hi:[1,1] neg_lo:[0,1] neg_hi:[0,1]
    v_pk_mul_f32 v[72:73], v[120:121], v[120:121]
    v_pk_fma_f32 v[72:73], v[122:123], v[122:123], v[72:73]
    v_pk_fma_f32 v[72:73], v[124:125], v[124:125], v[72:73]
    v_pk_fma_f32 v[72:73], v[126:127], v[126:127], v[72:73]
    v_add_f32 v72, v72, v73
    v_add_f32_dpp v60, v60, v60 row_shr:1 row_mask:0xf bank_mask:0xf
    v_add_f32_dpp v64, v64, v64 row_shr:1 row_mask:0xf bank_mask:0xf
    v_add_f32_dpp v68, v68, v68 row_shr:1 row_mask:0xf bank_mask:0xf
    v_add_f32_dpp v72, v72, v72 row_shr:1 row_mask:0xf bank_mask:0xf
    v_add_f32_dpp v60, v60, v60 row_shr:2 row_mask:0xf bank_mask:0xf
    v_add_f32_dpp v64, v64, v64 row_shr:2 row_mask:0xf bank_mask:0xf
    v_add_f32_dpp v68, v68, v68 row_shr:2 row_mask:0xf bank_mask:0xf
    v_add_f32_dpp v72, v72, v72 row_shr:2 row_mask:0xf bank_mask:0xf
    v_add_f32_dpp v60, v60, v60 row_shr:4 row_mask:0xf bank_mask:0xf
    v_add_f32_dpp v64, v64, v64 row_shr:4 row_mask:0xf bank_mask:0xf
    v_add_f32_dpp v68, v68, v68 row_shr:4 row_mask:0xf bank_mask:0xf
    v_add_f32_dpp v72, v72, v72 row_shr:4 row_mask:0xf bank_mask:0xf
    v_add_f32_dpp v60, v60, v60 row_shr:8 row_mask:0xf bank_mask:0xf
    v_add_f32_dpp v64, v64, v64 row_shr:8 row_mask:0xf bank_mask:0xf
    v_add_f32_dpp v68, v68, v68 row_shr:8 row_mask:0xf bank_mask:0xf
    v_add_f32_dpp v72, v72, v72 row_shr:8 row_mask:0xf bank_mask:0xf
    v_add_f32_dpp v60, v60, v60 row_bcast:15 row_mask:0xa bank_mask:0xf
    v_add_f32_dpp v64, v64, v64 row_bcast:15 row_mask:0xa bank_mask:0xf
    v_add_f32_dpp v68, v68, v68 row_bcast:15 row_mask:0xa bank_mask:0xf
    v_add_f32_dpp v72, v72, v72 row_bcast:15 row_mask:0xa bank_mask:0xf
    v_add_f32_dpp v60, v60, v60 row_bcast:31 row_mask:0xc bank_mask:0xf
    v_add_f32_dpp v64, v64, v64 row_bcast:31 row_mask:0xc bank_mask:0xf
    v_add_f32_dpp v68, v68, v68 row_bcast:31 row_mask:0xc bank_mask:0xf
    v_add_f32_dpp v72, v72, v72 row_bcast:31 row_mask:0xc bank_mask:0xf
    v_readlane_b32 s70, v60, 63
    v_readlane_b32 s71, v64, 63
    v_readlane_b32 s64, v68, 63
    v_readlane_b32 s65, v72, 63
    v_mov_b32 v88, s70
    v_mul_f32 v88, s3, v88
    v_mov_b32 v89, s71
    v_mul_f32 v89, s3, v89
    v_mov_b32 v90, s64
    v_mul_f32 v90, s3, v90
    v_mov_b32 v91, s65
    v_mul_f32 v91, s3, v91
    v_cvt_pk_bf16_f32 v88, 0, v88
    v_cvt_pk_bf16_f32 v89, 0, v89
    v_cvt_pk_bf16_f32 v90, 0, v90
    v_cvt_pk_bf16_f32 v91, 0, v91
    v_add_f32 v88, 0x3727c5ac, v88
    v_add_f32 v89, 0x3727c5ac, v89
    v_add_f32 v90, 0x3727c5ac, v90
    v_add_f32 v91, 0x3727c5ac, v91
    v_cvt_pk_bf16_f32 v88, 0, v88
    v_cvt_pk_bf16_f32 v89, 0, v89
    v_cvt_pk_bf16_f32 v90, 0, v90
    v_cvt_pk_bf16_f32 v91, 0, v91
    v_sqrt_f32 v88, v88
    v_sqrt_f32 v89, v89
    v_sqrt_f32 v90, v90
    v_sqrt_f32 v91, v91
    v_cvt_pk_bf16_f32 v88, 0, v88
    v_cvt_pk_bf16_f32 v89, 0, v89
    v_cvt_pk_bf16_f32 v90, 0, v90
    v_cvt_pk_bf16_f32 v91, 0, v91
    v_rcp_f32 v88, v88
    v_rcp_f32 v89, v89
    v_rcp_f32 v90, v90
    v_rcp_f32 v91, v91
    v_cvt_pk_bf16_f32 v84, 0, v84
    v_cvt_pk_bf16_f32 v85, 0, v85
    v_cvt_pk_bf16_f32 v86, 0, v86
    v_cvt_pk_bf16_f32 v87, 0, v87
    s_lshl_b32 s70, s74, 5
    s_lshl_b32 s71, s82, 4
    s_add_u32 s70, s70, s71
    s_add_u32 s70, s70, 21037056
    s_add_u32 s71, s70, 8192
    s_mov_b64 exec, 1
    buffer_store_dwordx4 v[84:87], v56, s[40:43], s70 offen sc1
    buffer_store_dwordx4 v[88:91], v56, s[40:43], s71 offen sc1
    s_mov_b64 exec, -1
    s_waitcnt vmcnt(11)
    v_lshlrev_b32 v14, 16, v11
    v_and_b32 v15, s5, v11
    s_mov_b32 s3, 0xbfb8aa3b
    v_mul_f32 v16, s3, v14
    v_mul_f32 v17, s3, v15
    v_exp_f32 v16, v16
    v_exp_f32 v17, v17
    v_add_f32 v16, 1.0, v16
    v_add_f32 v17, 1.0, v17
    v_rcp_f32 v16, v16
    v_rcp_f32 v17, v17
    v_mul_f32 v14, v14, v16
    v_mul_f32 v15, v15, v17
    v_cvt_pk_bf16_f32 v14, v14, v15
    s_lshl_b32 s3, s4, 8
    s_add_u32 s3, s3, 68096
    v_add_u32 v10, s3, v10
    ds_write_b32 v10, v14
    v_lshl_add_u32 v10, v3, 4, s3
    v_lshl_add_u32 v17, v3, 3, v4
    v_lshlrev_b32 v18, 7, v17
    v_lshl_add_u32 v18, v5, 3, v18
    s_lshl_b32 s3, s82, 6
    s_add_u32 s3, s3, 51712
    v_add_u32 v18, s3, v18
    v_lshlrev_b32 v19, 4, v3
    s_mul_i32 s75, s63, 12288
    s_lshl_b32 s3, s62, 8
    s_add_u32 s75, s75, s3
    s_lshl_b32 s3, s82, 7
    s_add_u32 s75, s75, s3
    s_add_u32 s75, s75, 20971520
    s_cmp_lt_u32 s2, 192
    s_cselect_b32 s75, s75, 0x7ff00000
    s_mov_b32 s7, 0
    s_nop 0
NONCE_PX:
    s_waitcnt vmcnt(6)
    v_readfirstlane_b32 s60, v58
    v_readfirstlane_b32 s61, v59
    s_add_u32 s7, s7, 1
    s_cmp_gt_u32 s7, 20000
    s_nop 2
    s_cbranch_scc1 NONCE_OKX
    s_cmp_lg_u32 s60, 0
    s_nop 0
    s_cbranch_scc1 NONCE_OKX
    buffer_load_dwordx2 v[58:59], v56, s[56:59], 0 offen sc1
    s_waitcnt vmcnt(0)
    s_nop 0
    s_branch NONCE_PX
    s_nop 0
NONCE_OKX:
    s_waitcnt vmcnt(2)
    s_lshl_b32 s3, s2, 2
    s_add_u32 s3, s3, s4
    s_lshl_b32 s3, s3, 6
    s_add_u32 s3, s3, 22167552
    v_mov_b32 v92, s60
    v_mov_b32 v93, s61
    v_mov_b32 v94, 0
    s_mov_b64 exec, 1
    buffer_store_dwordx2 v[92:93], v94, s[40:43], s3 offen sc1
    s_mov_b64 exec, -1
    s_barrier
    ds_read_b64_tr_b16 v[192:193], v212 offset:43520
    ds_read_b64_tr_b16 v[194:195], v212 offset:44032
    ds_read_b64_tr_b16 v[196:197], v212 offset:47616
    ds_read_b64_tr_b16 v[198:199], v212 offset:48128
    ds_read_b64_tr_b16 v[200:201], v212 offset:43552
    ds_read_b64_tr_b16 v[202:203], v212 offset:44064
    ds_read_b64_tr_b16 v[204:205], v212 offset:47648
    ds_read_b64_tr_b16 v[206:207], v212 offset:48160
    ds_read_b128 v[20:23], v10 offset:0
    ds_read_b128 v[24:27], v10 offset:64
    ds_read_b128 v[28:31], v10 offset:128
    ds_read_b128 v[32:35], v10 offset:192
    ds_read_b64_tr_b16 v[96:97], v18 offset:0
    ds_read_b64_tr_b16 v[98:99], v18 offset:512
    ds_read_b64_tr_b16 v[100:101], v18 offset:4096
    ds_read_b64_tr_b16 v[102:103], v18 offset:4608
    ds_read_b64_tr_b16 v[104:105], v18 offset:8192
    ds_read_b64_tr_b16 v[106:107], v18 offset:8704
    ds_read_b64_tr_b16 v[108:109], v18 offset:12288
    ds_read_b64_tr_b16 v[110:111], v18 offset:12800
    ds_read_b64_tr_b16 v[112:113], v18 offset:32
    ds_read_b64_tr_b16 v[114:115], v18 offset:544
    ds_read_b64_tr_b16 v[116:117], v18 offset:4128
    ds_read_b64_tr_b16 v[118:119], v18 offset:4640
    ds_read_b64_tr_b16 v[120:121], v18 offset:8224
    ds_read_b64_tr_b16 v[122:123], v18 offset:8736
    ds_read_b64_tr_b16 v[124:125], v18 offset:12320
    ds_read_b64_tr_b16 v[126:127], v18 offset:12832
    s_mov_b32 s68, 0x00010001
    s_mov_b32 s69, 0x00010001
    s_waitcnt lgkmcnt(14)
    v_mfma_f32_16x16x32_bf16 v[48:51], v[96:99], v[20:23], 0
    s_waitcnt lgkmcnt(12)
    v_mfma_f32_16x16x32_bf16 v[48:51], v[100:103], v[24:27], v[48:51]
    s_waitcnt lgkmcnt(10)
    v_mfma_f32_16x16x32_bf16 v[48:51], v[104:107], v[28:31], v[48:51]
    s_waitcnt lgkmcnt(8)
    v_mfma_f32_16x16x32_bf16 v[48:51], v[108:111], v[32:35], v[48:51]
    s_waitcnt lgkmcnt(6)
    v_mfma_f32_16x16x32_bf16 v[52:55], v[112:115], v[20:23], 0
    s_waitcnt lgkmcnt(4)
    v_mfma_f32_16x16x32_bf16 v[52:55], v[116:119], v[24:27], v[52:55]
    s_waitcnt lgkmcnt(2)
    v_mfma_f32_16x16x32_bf16 v[52:55], v[120:123], v[28:31], v[52:55]
    s_waitcnt lgkmcnt(0)
    v_mfma_f32_16x16x32_bf16 v[52:55], v[124:127], v[32:35], v[52:55]
    s_mov_b64 exec, s[68:69]
    buffer_store_dwordx4 v[48:51], v19, s[40:43], s75 offen offset:0 sc1
    s_nop 5
    buffer_store_dwordx4 v[52:55], v19, s[40:43], s75 offen offset:64 sc1
    s_mov_b64 exec, -1
    buffer_store_dwordx4 v[192:195], v213, s[40:43], s78 offen offset:0 sc1
    buffer_store_dwordx4 v[196:199], v213, s[40:43], s78 offen offset:128 sc1
    buffer_store_dwordx4 v[200:203], v213, s[40:43], s79 offen offset:0 sc1
    buffer_store_dwordx4 v[204:207], v213, s[40:43], s79 offen offset:128 sc1
    s_lshr_b32 s3, s2, 5
    s_lshl_b32 s3, s3, 2
    s_bfe_u32 s6, s2, 0x10004
    s_add_u32 s3, s3, s6
    s_lshl_b32 s3, s3, 6
    s_add_u32 s3, s3, 131072
    v_lshl_add_u32 v13, v2, 11, s3
    s_mov_b64 exec, 0xffffffff
    s_mov_b32 s6, 22036480
    buffer_load_dwordx2 v[58:59], v13, s[40:43], s6 offen offset:0 sc1
    s_mov_b64 exec, -1
    s_lshr_b32 s70, s4, 1
    s_and_b32 s71, s4, 1
    v_mov_b32 v88, 0
    v_mov_b32 v89, 0
    v_mov_b32 v90, 0
    v_mov_b32 v91, 0
    s_mul_i32 s64, s4, 4160
    s_add_u32 s64, s64, 85504
    s_mul_i32 s65, s70, 4288
    s_add_u32 s65, s65, 8320
    s_mul_i32 s3, s70, 8704
    s_add_u32 s3, s3, 18944
    v_add_u32 v92, s64, v6
    v_add_u32 v93, s65, v6
    v_add_u32 v94, s3, v6
    s_mov_b64 exec, 0xf
    ds_write_b128 v92, v[88:91]
    s_mov_b64 exec, 0xfff
    ds_write_b128 v93, v[88:91]
    s_mov_b64 exec, 0x3f
    ds_write_b128 v94, v[88:91] offset:0
    ds_write_b128 v94, v[88:91] offset:2176
    ds_write_b128 v94, v[88:91] offset:4352
    ds_write_b128 v94, v[88:91] offset:6528
    s_mov_b64 exec, -1
    s_lshl_b32 s3, s71, 5
    s_add_u32 s64, s64, s3
    s_add_u32 s64, s64, 224
    v_sub_u32 v92, v5, v4
    v_lshlrev_b32 v92, 3, v92
    v_lshlrev_b32 v93, 6, v3
    v_sub_u32 v92, v92, v93
    v_add_u32 v92, s64, v92
    ds_read_b64_tr_b16 a[0:1], v92 offset:32
    ds_read_b64_tr_b16 a[2:3], v92 offset:0
    ds_read_b64_tr_b16 a[4:5], v92 offset:288
    ds_read_b64_tr_b16 a[6:7], v92 offset:256
    ds_read_b64_tr_b16 a[8:9], v92 offset:544
    ds_read_b64_tr_b16 a[10:11], v92 offset:512
    ds_read_b64_tr_b16 a[12:13], v92 offset:800
    ds_read_b64_tr_b16 a[14:15], v92 offset:768
    ds_read_b64_tr_b16 a[16:17], v92 offset:1056
    ds_read_b64_tr_b16 a[18:19], v92 offset:1024
    ds_read_b64_tr_b16 a[20:21], v92 offset:1312
    ds_read_b64_tr_b16 a[22:23], v92 offset:1280
    ds_read_b64_tr_b16 a[24:25], v92 offset:1568
    ds_read_b64_tr_b16 a[26:27], v92 offset:1536
    ds_read_b64_tr_b16 a[28:29], v92 offset:1824
    ds_read_b64_tr_b16 a[30:31], v92 offset:1792
    ds_read_b64_tr_b16 a[32:33], v92 offset:2080
    ds_read_b64_tr_b16 a[34:35], v92 offset:2048
    ds_read_b64_tr_b16 a[36:37], v92 offset:2336
    ds_read_b64_tr_b16 a[38:39], v92 offset:2304
    ds_read_b64_tr_b16 a[40:41], v92 offset:2592
    ds_read_b64_tr_b16 a[42:43], v92 offset:2560
    ds_read_b64_tr_b16 a[44:45], v92 offset:2848
    ds_read_b64_tr_b16 a[46:47], v92 offset:2816
    ds_read_b64_tr_b16 a[48:49], v92 offset:3104
    ds_read_b64_tr_b16 a[50:51], v92 offset:3072
    ds_read_b64_tr_b16 a[52:53], v92 offset:3360
    ds_read_b64_tr_b16 a[54:55], v92 offset:3328
    ds_read_b64_tr_b16 a[56:57], v92 offset:3616
    ds_read_b64_tr_b16 a[58:59], v92 offset:3584
    ds_read_b64_tr_b16 a[60:61], v92 offset:3872
    ds_read_b64_tr_b16 a[62:63], v92 offset:3840
    s_waitcnt vmcnt(1)
    s_lshl_b32 s3, s2, 2
    s_add_u32 s3, s3, s4
    s_lshl_b32 s3, s3, 6
    s_add_u32 s3, s3, 22102016
    v_mov_b32 v88, s60
    v_mov_b32 v89, s61
    v_mov_b32 v90, 0
    s_mov_b64 exec, 1
    buffer_store_dwordx2 v[88:89], v90, s[40:43], s3 offen sc1
    s_mov_b64 exec, -1
    s_lshr_b32 s16, s4, 1
    s_and_b32 s17, s4, 1
    s_lshl_b32 s18, s2, 1
    s_add_u32 s18, s18, s16
    s_mul_i32 s19, s18, 4352
    s_lshl_b32 s64, s17, 11
    s_add_u32 s65, s19, s64
    s_mul_i32 s20, s16, 4288
    s_add_u32 s20, s20, 8320
    s_add_u32 s64, s64, s20
    s_add_u32 s64, s64, 192
    s_mov_b32 m0, s64
    v_mov_b32 v210, v14
    v_mov_b32 v211, v15
    v_lshrrev_b32 v12, 2, v2
    v_lshlrev_b32 v12, 7, v12
    v_lshl_add_u32 v12, v5, 4, v12
    s_mul_i32 s65, s2, 8448
    s_lshl_b32 s3, s17, 12
    s_add_u32 s65, s65, s3
    s_lshl_b32 s3, s16, 6
    s_add_u32 s65, s65, s3
    s_add_u32 s66, s65, 1024
    s_mov_b32 s7, 0
    s_nop 0
PL1:
    s_waitcnt vmcnt(1)
    v_cmp_ne_u64 vcc, s[60:61], v[58:59]
    s_nop 0
    s_and_b64 vcc, vcc, 0xffffffff
    s_add_u32 s7, s7, 1
    s_cmp_gt_u32 s7, 20000
    s_cselect_b64 vcc, 0, vcc
    s_cmp_eq_u64 vcc, 0
    s_nop 0
    s_cbranch_scc1 PL1D
    s_mov_b64 exec, 0xffffffff
    s_mov_b32 s6, 22036480
    buffer_load_dwordx2 v[58:59], v13, s[40:43], s6 offen offset:0 sc1
    s_mov_b64 exec, -1
    s_waitcnt vmcnt(0)
    s_nop 0
    s_branch PL1
    s_nop 0
PL1D:
    buffer_load_dwordx4 v12, s[40:43], s65 offen  lds
    buffer_load_dwordx4 v12, s[40:43], s66 offen offset:1024  lds
    s_waitcnt lgkmcnt(0)
    s_nop 0
    s_branch JOIN
    s_nop 0
PATH_Y:
    buffer_load_dwordx4 v[140:143], v16, s[44:47], 0 offen nt
    buffer_load_dwordx4 v[144:147], v16, s[44:47], 0 offen offset:1024 nt
    buffer_load_dwordx4 v[148:151], v16, s[48:51], 0 offen nt
    buffer_load_dwordx4 v[152:155], v16, s[48:51], 0 offen offset:1024 nt
    buffer_load_dwordx4 v[156:159], v17, s[52:55], s68 offen offset:0 nt
    buffer_load_dwordx4 v[160:163], v17, s[52:55], s68 offen offset:16 nt
    buffer_load_dwordx4 v[164:167], v17, s[52:55], s68 offen offset:32 nt
    buffer_load_dwordx4 v[168:171], v17, s[52:55], s68 offen offset:48 nt
    buffer_load_dwordx4 v[128:131], v13, s[44:47], 0 offen nt
    buffer_load_dwordx4 v[132:135], v14, s[44:47], 0 offen nt
    buffer_load_dwordx4 v[136:139], v15, s[44:47], 0 offen nt
    s_mov_b32 s56, s36
    s_mov_b32 s57, s37
    s_mov_b32 s58, 256
    s_mov_b32 s59, 0x20000
    s_lshl_b32 s3, s2, 2
    s_add_u32 s6, s18, s3
    s_addc_u32 s7, s19, 0
    s_load_dword s81, s[6:7], 0
    v_mul_u32_u24 v9, 6144, v8
    v_lshl_add_u32 v9, v7, 4, v9
    v_lshlrev_b32 v218, 10, v8
    v_lshl_add_u32 v218, v7, 4, v218
    v_lshrrev_b32 v219, 2, v2
    v_mul_u32_u24 v219, 2752, v219
    v_lshl_add_u32 v219, v5, 4, v219
    s_mov_b32 s44, s32
    s_mov_b32 s45, s33
    s_mov_b32 s46, 3145728
    s_mov_b32 s47, 0x20000
    s_lshl_b32 s64, s63, 1
    s_add_u32 s64, s64, s82
    s_mul_i32 s64, s64, 393216
    s_lshl_b32 s65, s62, 7
    s_add_u32 s64, s64, s65
    s_lshl_b32 s65, s82, 13
    s_add_u32 s65, s65, 51712
    s_mov_b32 m0, s65
    s_nop 0
    buffer_load_dwordx4 v9, s[44:47], s64 offen nt lds
    s_add_u32 s64, s64, 49152
    s_add_u32 s65, s65, 1024
    s_mov_b32 m0, s65
    s_nop 0
    buffer_load_dwordx4 v9, s[44:47], s64 offen nt lds
    s_add_u32 s64, s64, 49152
    s_add_u32 s65, s65, 1024
    s_mov_b32 m0, s65
    s_nop 0
    buffer_load_dwordx4 v9, s[44:47], s64 offen nt lds
    s_add_u32 s64, s64, 49152
    s_add_u32 s65, s65, 1024
    s_mov_b32 m0, s65
    s_nop 0
    buffer_load_dwordx4 v9, s[44:47], s64 offen nt lds
    s_waitcnt vmcnt(10)
    v_lshlrev_b32 v74, 16, v156
    v_lshlrev_b32 v75, 16, v158
    v_and_b32 v76, s5, v156
    v_and_b32 v77, s5, v158
    v_lshlrev_b32 v78, 16, v157
    v_lshlrev_b32 v79, 16, v159
    v_and_b32 v80, s5, v157
    v_and_b32 v81, s5, v159
    s_waitcnt vmcnt(6)
    v_lshlrev_b32 v60, 16, v128
    v_and_b32 v61, s5, v128
    s_waitcnt vmcnt(5)
    v_lshlrev_b32 v62, 16, v132
    v_and_b32 v63, s5, v132
    s_waitcnt vmcnt(4)
    v_lshlrev_b32 v64, 16, v136
    v_and_b32 v65, s5, v136
    v_lshlrev_b32 v66, 16, v140
    v_and_b32 v67, s5, v140
    v_lshlrev_b32 v68, 16, v144
    v_and_b32 v69, s5, v144
    v_pk_mul_f32 v[82:83], v[60:61], v[80:81]
    v_pk_mul_f32 v[84:85], v[62:63], v[80:81]
    v_pk_fma_f32 v[82:83], v[62:63], v[78:79], v[82:83]
    v_pk_fma_f32 v[84:85], v[64:65], v[78:79], v[84:85]
    v_pk_fma_f32 v[82:83], v[64:65], v[76:77], v[82:83]
    v_pk_fma_f32 v[84:85], v[66:67], v[76:77], v[84:85]
    v_pk_fma_f32 v[82:83], v[66:67], v[74:75], v[82:83]
    v_pk_fma_f32 v[84:85], v[68:69], v[74:75], v[84:85]
    v_lshlrev_b32 v70, 16, v148
    v_and_b32 v71, s5, v148
    v_lshlrev_b32 v72, 16, v152
    v_and_b32 v73, s5, v152
    s_add_u32 s64, s64, 49152
    s_add_u32 s65, s65, 1024
    s_mov_b32 m0, s65
    s_nop 0
    buffer_load_dwordx4 v9, s[44:47], s64 offen nt lds
    v_cvt_pk_bf16_f32 v82, 0, v82
    v_cvt_pk_bf16_f32 v83, 0, v83
    v_cvt_pk_bf16_f32 v84, 0, v84
    v_cvt_pk_bf16_f32 v85, 0, v85
    v_pk_mul_f32 v[82:83], v[82:83], v[70:71]
    v_pk_mul_f32 v[84:85], v[84:85], v[72:73]
    v_cvt_pk_bf16_f32 v92, v82, v83
    v_cvt_pk_bf16_f32 v96, v84, v85
    v_lshlrev_b32 v74, 16, v160
    v_lshlrev_b32 v75, 16, v162
    v_and_b32 v76, s5, v160
    v_and_b32 v77, s5, v162
    v_lshlrev_b32 v78, 16, v161
    v_lshlrev_b32 v79, 16, v163
    v_and_b32 v80, s5, v161
    v_and_b32 v81, s5, v163
    v_lshlrev_b32 v60, 16, v129
    v_and_b32 v61, s5, v129
    v_lshlrev_b32 v62, 16, v133
    v_and_b32 v63, s5, v133
    v_lshlrev_b32 v64, 16, v137
    v_and_b32 v65, s5, v137
    v_lshlrev_b32 v66, 16, v141
    v_and_b32 v67, s5, v141
    v_lshlrev_b32 v68, 16, v145
    v_and_b32 v69, s5, v145
    v_pk_mul_f32 v[82:83], v[60:61], v[80:81]
    v_pk_mul_f32 v[84:85], v[62:63], v[80:81]
    v_pk_fma_f32 v[82:83], v[62:63], v[78:79], v[82:83]
    v_pk_fma_f32 v[84:85], v[64:65], v[78:79], v[84:85]
    s_add_u32 s64, s64, 49152
    s_add_u32 s65, s65, 1024
    s_mov_b32 m0, s65
    s_nop 0
    buffer_load_dwordx4 v9, s[44:47], s64 offen nt lds
    v_pk_fma_f32 v[82:83], v[64:65], v[76:77], v[82:83]
    v_pk_fma_f32 v[84:85], v[66:67], v[76:77], v[84:85]
    v_pk_fma_f32 v[82:83], v[66:67], v[74:75], v[82:83]
    v_pk_fma_f32 v[84:85], v[68:69], v[74:75], v[84:85]
    v_lshlrev_b32 v70, 16, v149
    v_and_b32 v71, s5, v149
    v_lshlrev_b32 v72, 16, v153
    v_and_b32 v73, s5, v153
    v_cvt_pk_bf16_f32 v82, 0, v82
    v_cvt_pk_bf16_f32 v83, 0, v83
    v_cvt_pk_bf16_f32 v84, 0, v84
    v_cvt_pk_bf16_f32 v85, 0, v85
    v_pk_mul_f32 v[82:83], v[82:83], v[70:71]
    v_pk_mul_f32 v[84:85], v[84:85], v[72:73]
    v_cvt_pk_bf16_f32 v93, v82, v83
    v_cvt_pk_bf16_f32 v97, v84, v85
    v_lshlrev_b32 v74, 16, v164
    v_lshlrev_b32 v75, 16, v166
    v_and_b32 v76, s5, v164
    v_and_b32 v77, s5, v166
    v_lshlrev_b32 v78, 16, v165
    v_lshlrev_b32 v79, 16, v167
    v_and_b32 v80, s5, v165
    v_and_b32 v81, s5, v167
    v_lshlrev_b32 v60, 16, v130
    v_and_b32 v61, s5, v130
    v_lshlrev_b32 v62, 16, v134
    v_and_b32 v63, s5, v134
    v_lshlrev_b32 v64, 16, v138
    v_and_b32 v65, s5, v138
    s_add_u32 s64, s64, 49152
    s_add_u32 s65, s65, 1024
    s_mov_b32 m0, s65
    s_nop 0
    buffer_load_dwordx4 v9, s[44:47], s64 offen nt lds
    v_lshlrev_b32 v66, 16, v142
    v_and_b32 v67, s5, v142
    v_lshlrev_b32 v68, 16, v146
    v_and_b32 v69, s5, v146
    v_pk_mul_f32 v[82:83], v[60:61], v[80:81]
    v_pk_mul_f32 v[84:85], v[62:63], v[80:81]
    v_pk_fma_f32 v[82:83], v[62:63], v[78:79], v[82:83]
    v_pk_fma_f32 v[84:85], v[64:65], v[78:79], v[84:85]
    v_pk_fma_f32 v[82:83], v[64:65], v[76:77], v[82:83]
    v_pk_fma_f32 v[84:85], v[66:67], v[76:77], v[84:85]
    v_pk_fma_f32 v[82:83], v[66:67], v[74:75], v[82:83]
    v_pk_fma_f32 v[84:85], v[68:69], v[74:75], v[84:85]
    v_lshlrev_b32 v70, 16, v150
    v_and_b32 v71, s5, v150
    v_lshlrev_b32 v72, 16, v154
    v_and_b32 v73, s5, v154
    v_cvt_pk_bf16_f32 v82, 0, v82
    v_cvt_pk_bf16_f32 v83, 0, v83
    v_cvt_pk_bf16_f32 v84, 0, v84
    v_cvt_pk_bf16_f32 v85, 0, v85
    v_pk_mul_f32 v[82:83], v[82:83], v[70:71]
    v_pk_mul_f32 v[84:85], v[84:85], v[72:73]
    v_cvt_pk_bf16_f32 v94, v82, v83
    v_cvt_pk_bf16_f32 v98, v84, v85
    v_lshlrev_b32 v74, 16, v168
    v_lshlrev_b32 v75, 16, v170
    v_and_b32 v76, s5, v168
    v_and_b32 v77, s5, v170
    v_lshlrev_b32 v78, 16, v169
    v_lshlrev_b32 v79, 16, v171
    s_add_u32 s64, s64, 49152
    s_add_u32 s65, s65, 1024
    s_mov_b32 m0, s65
    s_nop 0
    buffer_load_dwordx4 v9, s[44:47], s64 offen nt lds
    v_and_b32 v80, s5, v169
    v_and_b32 v81, s5, v171
    v_lshlrev_b32 v60, 16, v131
    v_and_b32 v61, s5, v131
    v_lshlrev_b32 v62, 16, v135
    v_and_b32 v63, s5, v135
    v_lshlrev_b32 v64, 16, v139
    v_and_b32 v65, s5, v139
    v_lshlrev_b32 v66, 16, v143
    v_and_b32 v67, s5, v143
    v_lshlrev_b32 v68, 16, v147
    v_and_b32 v69, s5, v147
    v_pk_mul_f32 v[82:83], v[60:61], v[80:81]
    v_pk_mul_f32 v[84:85], v[62:63], v[80:81]
    v_pk_fma_f32 v[82:83], v[62:63], v[78:79], v[82:83]
    v_pk_fma_f32 v[84:85], v[64:65], v[78:79], v[84:85]
    v_pk_fma_f32 v[82:83], v[64:65], v[76:77], v[82:83]
    v_pk_fma_f32 v[84:85], v[66:67], v[76:77], v[84:85]
    v_pk_fma_f32 v[82:83], v[66:67], v[74:75], v[82:83]
    v_pk_fma_f32 v[84:85], v[68:69], v[74:75], v[84:85]
    v_lshlrev_b32 v70, 16, v151
    v_and_b32 v71, s5, v151
    v_lshlrev_b32 v72, 16, v155
    v_and_b32 v73, s5, v155
    v_cvt_pk_bf16_f32 v82, 0, v82
    v_cvt_pk_bf16_f32 v83, 0, v83
    v_cvt_pk_bf16_f32 v84, 0, v84
    v_cvt_pk_bf16_f32 v85, 0, v85
    v_pk_mul_f32 v[82:83], v[82:83], v[70:71]
    v_pk_mul_f32 v[84:85], v[84:85], v[72:73]
    v_cvt_pk_bf16_f32 v95, v82, v83
    v_cvt_pk_bf16_f32 v99, v84, v85
    ds_write_b128 v18, v[92:95] offset:34304
    ds_write_b128 v18, v[96:99] offset:34448
    s_waitcnt lgkmcnt(0)
    s_barrier
    buffer_load_dwordx2 v[58:59], v56, s[56:59], 0 offen sc1
    s_mov_b32 s44, s22
    s_mov_b32 s45, s23
    s_mov_b32 s46, 1409024
    s_mov_b32 s47, 0x20000
    s_mul_i32 s64, s67, 176128
    s_lshl_b32 s65, s66, 6
    s_add_u32 s64, s64, s65
    s_lshl_b32 s65, s82, 11
    s_add_u32 s64, s64, s65
    s_lshl_b32 s65, s82, 12
    s_add_u32 s65, s65, 77312
    s_mov_b32 m0, s65
    s_nop 0
    buffer_load_dwordx4 v219, s[44:47], s64 offen nt lds
    s_add_u32 s64, s64, 44032
    s_add_u32 s65, s65, 1024
    s_mov_b32 m0, s65
    s_nop 0
    buffer_load_dwordx4 v219, s[44:47], s64 offen nt lds
    s_add_u32 s64, s64, 44032
    s_add_u32 s65, s65, 1024
    s_mov_b32 m0, s65
    s_nop 0
    buffer_load_dwordx4 v219, s[44:47], s64 offen nt lds
    s_add_u32 s64, s64, 44032
    s_add_u32 s65, s65, 1024
    s_mov_b32 m0, s65
    s_nop 0
    buffer_load_dwordx4 v219, s[44:47], s64 offen nt lds
    s_mov_b32 s52, s26
    s_mov_b32 s53, s27
    s_mov_b32 s54, 1409024
    s_mov_b32 s55, 0x20000
    s_lshl_b32 s64, s66, 15
    s_lshl_b32 s65, s82, 20
    s_add_u32 s64, s64, s65
    s_lshl_b32 s65, s67, 7
    s_add_u32 s64, s64, s65
    s_lshl_b32 s65, s82, 12
    s_add_u32 s65, s65, 69120
    s_mov_b32 m0, s65
    s_nop 0
    buffer_load_dwordx4 v218, s[52:55], s64 offen nt lds
    s_add_u32 s64, s64, 8192
    s_add_u32 s65, s65, 1024
    s_mov_b32 m0, s65
    s_nop 0
    buffer_load_dwordx4 v218, s[52:55], s64 offen nt lds
    s_add_u32 s64, s64, 8192
    s_add_u32 s65, s65, 1024
    s_mov_b32 m0, s65
    s_nop 0
    buffer_load_dwordx4 v218, s[52:55], s64 offen nt lds
    s_add_u32 s64, s64, 8192
    s_add_u32 s65, s65, 1024
    s_mov_b32 m0, s65
    s_nop 0
    buffer_load_dwordx4 v218, s[52:55], s64 offen nt lds
    s_mov_b32 s44, s16
    s_mov_b32 s45, s17
    s_mov_b32 s46, 2097152
    s_mov_b32 s47, 0x20000
    s_lshl_b32 s64, s2, 13
    s_lshr_b32 s65, s4, 1
    s_lshl_b32 s65, s65, 12
    s_add_u32 s64, s64, s65
    s_mul_i32 s65, s4, 4160
    s_add_u32 s65, s65, 85568
    s_mov_b32 m0, s65
    s_nop 0
    buffer_load_dwordx4 v6, s[44:47], s64 offen nt lds
    buffer_load_dwordx4 v6, s[44:47], s64 offen offset:1024 nt lds
    buffer_load_dwordx4 v6, s[44:47], s64 offen offset:2048 nt lds
    buffer_load_dwordx4 v6, s[44:47], s64 offen offset:3072 nt lds
    v_lshl_add_u32 v17, v3, 3, v4
    v_lshl_add_u32 v14, v3, 2, v4
    v_lshlrev_b32 v14, 7, v14
    v_lshl_add_u32 v14, v5, 5, v14
    s_lshl_b32 s64, s82, 12
    s_add_u32 s65, s64, 69120
    v_add_u32 v14, s65, v14
    v_lshlrev_b32 v15, 6, v17
    v_lshl_add_u32 v15, v5, 3, v15
    s_add_u32 s65, s64, 77312
    v_add_u32 v15, s65, v15
    s_lshl_b32 s64, s82, 5
    s_add_u32 s64, s64, s66
    s_and_b32 s62, s66, 7
    s_lshl_b32 s62, s62, 2
    s_lshr_b32 s3, s66, 3
    s_lshl_b32 s3, s3, 1
    s_add_u32 s62, s62, s3
    s_cmp_eq_u32 s82, 0
    s_cselect_b32 s62, s66, s62
    s_cselect_b32 s75, 1, 48
    s_cselect_b32 s6, 0, 2048
    s_mul_i32 s62, s62, 49152
    s_mul_i32 s3, s67, 6144
    s_add_u32 s62, s62, s3
    s_add_u32 s62, s62, s6
    s_add_u32 s62, s62, 16777216
    s_lshl_b32 s75, s75, 10
    s_add_u32 s75, s75, s62
    s_lshl_b32 s63, s67, 2
    s_and_b32 s3, s64, 3
    s_add_u32 s63, s63, s3
    s_mul_i32 s63, s63, 11
    s_lshr_b32 s3, s64, 2
    s_add_u32 s63, s63, s3
    s_lshl_b32 s63, s63, 12
    s_add_u32 s63, s63, 18874368
    s_cmp_lt_u32 s64, 43
    s_cselect_b32 s62, s62, 0x7ff00000
    s_cselect_b32 s75, s75, 0x7ff00000
    s_cselect_b32 s63, s63, 0x7ff00000
    s_mov_b32 s7, 0
    s_nop 0
NONCE_PY:
    s_waitcnt vmcnt(12)
    v_readfirstlane_b32 s60, v58
    v_readfirstlane_b32 s61, v59
    s_add_u32 s7, s7, 1
    s_cmp_gt_u32 s7, 20000
    s_nop 2
    s_cbranch_scc1 NONCE_OKY
    s_cmp_lg_u32 s60, 0
    s_nop 0
    s_cbranch_scc1 NONCE_OKY
    buffer_load_dwordx2 v[58:59], v56, s[56:59], 0 offen sc1
    s_waitcnt vmcnt(0)
    s_nop 0
    s_branch NONCE_PY
    s_nop 0
NONCE_OKY:
    s_barrier
    s_lshr_b32 s70, s4, 1
    s_and_b32 s71, s4, 1
    v_mov_b32 v88, 0
    v_mov_b32 v89, 0
    v_mov_b32 v90, 0
    v_mov_b32 v91, 0
    s_mul_i32 s64, s4, 4160
    s_add_u32 s64, s64, 85504
    s_mul_i32 s65, s70, 4288
    s_add_u32 s65, s65, 8320
    s_mul_i32 s3, s70, 8704
    s_add_u32 s3, s3, 18944
    v_add_u32 v92, s64, v6
    v_add_u32 v93, s65, v6
    v_add_u32 v94, s3, v6
    s_mov_b64 exec, 0xf
    ds_write_b128 v92, v[88:91]
    s_mov_b64 exec, 0xfff
    ds_write_b128 v93, v[88:91]
    s_mov_b64 exec, 0x3f
    ds_write_b128 v94, v[88:91] offset:0
    ds_write_b128 v94, v[88:91] offset:2176
    ds_write_b128 v94, v[88:91] offset:4352
    ds_write_b128 v94, v[88:91] offset:6528
    s_mov_b64 exec, -1
    s_lshl_b32 s3, s71, 5
    s_add_u32 s64, s64, s3
    s_add_u32 s64, s64, 224
    v_sub_u32 v92, v5, v4
    v_lshlrev_b32 v92, 3, v92
    v_lshlrev_b32 v93, 6, v3
    v_sub_u32 v92, v92, v93
    v_add_u32 v92, s64, v92
    s_waitcnt vmcnt(8)
    ds_read_b64_tr_b16 v[20:21], v15 offset:0
    ds_read_b64_tr_b16 v[22:23], v15 offset:256
    ds_read_b64_tr_b16 v[24:25], v15 offset:2048
    ds_read_b64_tr_b16 v[26:27], v15 offset:2304
    ds_read_b64_tr_b16 v[28:29], v15 offset:32
    ds_read_b64_tr_b16 v[30:31], v15 offset:288
    ds_read_b64_tr_b16 v[32:33], v15 offset:2080
    ds_read_b64_tr_b16 v[34:35], v15 offset:2336
    s_waitcnt lgkmcnt(6)
    buffer_store_dwordx4 v[20:23], v6, s[40:43], s62 offen offset:0 sc1
    s_waitcnt lgkmcnt(4)
    buffer_store_dwordx4 v[24:27], v6, s[40:43], s62 offen offset:3072 sc1
    s_waitcnt lgkmcnt(2)
    buffer_store_dwordx4 v[28:31], v6, s[40:43], s75 offen offset:0 sc1
    s_waitcnt lgkmcnt(0)
    buffer_store_dwordx4 v[32:35], v6, s[40:43], s75 offen offset:3072 sc1
    s_waitcnt vmcnt(8)
    ds_read_b64_tr_b16 v[36:37], v14 offset:0
    ds_read_b64_tr_b16 v[38:39], v14 offset:2048
    ds_read_b64_tr_b16 v[40:41], v14 offset:8
    ds_read_b64_tr_b16 v[42:43], v14 offset:2056
    ds_read_b64_tr_b16 v[44:45], v14 offset:16
    ds_read_b64_tr_b16 v[46:47], v14 offset:2064
    ds_read_b64_tr_b16 v[48:49], v14 offset:24
    ds_read_b64_tr_b16 v[50:51], v14 offset:2072
    s_waitcnt lgkmcnt(6)
    buffer_store_dwordx4 v[36:39], v6, s[40:43], s63 offen offset:0 sc1
    s_waitcnt lgkmcnt(4)
    buffer_store_dwordx4 v[40:43], v6, s[40:43], s63 offen offset:1024 sc1
    s_waitcnt lgkmcnt(2)
    buffer_store_dwordx4 v[44:47], v6, s[40:43], s63 offen offset:2048 sc1
    s_waitcnt lgkmcnt(0)
    buffer_store_dwordx4 v[48:51], v6, s[40:43], s63 offen offset:3072 sc1
    s_lshr_b32 s3, s2, 5
    s_lshl_b32 s3, s3, 2
    s_bfe_u32 s6, s2, 0x10004
    s_add_u32 s3, s3, s6
    s_lshl_b32 s3, s3, 6
    s_add_u32 s3, s3, 131072
    v_lshl_add_u32 v13, v2, 11, s3
    s_mov_b64 exec, 0xffffffff
    s_mov_b32 s6, 22036480
    buffer_load_dwordx2 v[58:59], v13, s[40:43], s6 offen offset:0 sc1
    s_mov_b64 exec, -1
    s_waitcnt vmcnt(9)
    ds_read_b64_tr_b16 a[0:1], v92 offset:32
    ds_read_b64_tr_b16 a[2:3], v92 offset:0
    ds_read_b64_tr_b16 a[4:5], v92 offset:288
    ds_read_b64_tr_b16 a[6:7], v92 offset:256
    ds_read_b64_tr_b16 a[8:9], v92 offset:544
    ds_read_b64_tr_b16 a[10:11], v92 offset:512
    ds_read_b64_tr_b16 a[12:13], v92 offset:800
    ds_read_b64_tr_b16 a[14:15], v92 offset:768
    ds_read_b64_tr_b16 a[16:17], v92 offset:1056
    ds_read_b64_tr_b16 a[18:19], v92 offset:1024
    ds_read_b64_tr_b16 a[20:21], v92 offset:1312
    ds_read_b64_tr_b16 a[22:23], v92 offset:1280
    ds_read_b64_tr_b16 a[24:25], v92 offset:1568
    ds_read_b64_tr_b16 a[26:27], v92 offset:1536
    ds_read_b64_tr_b16 a[28:29], v92 offset:1824
    ds_read_b64_tr_b16 a[30:31], v92 offset:1792
    ds_read_b64_tr_b16 a[32:33], v92 offset:2080
    ds_read_b64_tr_b16 a[34:35], v92 offset:2048
    ds_read_b64_tr_b16 a[36:37], v92 offset:2336
    ds_read_b64_tr_b16 a[38:39], v92 offset:2304
    ds_read_b64_tr_b16 a[40:41], v92 offset:2592
    ds_read_b64_tr_b16 a[42:43], v92 offset:2560
    ds_read_b64_tr_b16 a[44:45], v92 offset:2848
    ds_read_b64_tr_b16 a[46:47], v92 offset:2816
    ds_read_b64_tr_b16 a[48:49], v92 offset:3104
    ds_read_b64_tr_b16 a[50:51], v92 offset:3072
    ds_read_b64_tr_b16 a[52:53], v92 offset:3360
    ds_read_b64_tr_b16 a[54:55], v92 offset:3328
    ds_read_b64_tr_b16 a[56:57], v92 offset:3616
    ds_read_b64_tr_b16 a[58:59], v92 offset:3584
    ds_read_b64_tr_b16 a[60:61], v92 offset:3872
    ds_read_b64_tr_b16 a[62:63], v92 offset:3840
    s_lshr_b32 s16, s4, 1
    s_and_b32 s17, s4, 1
    s_lshl_b32 s18, s2, 1
    s_add_u32 s18, s18, s16
    s_mul_i32 s19, s18, 4352
    s_lshl_b32 s64, s17, 11
    s_add_u32 s65, s19, s64
    s_mul_i32 s20, s16, 4288
    s_add_u32 s20, s20, 8320
    s_add_u32 s64, s64, s20
    s_add_u32 s64, s64, 192
    s_mov_b32 m0, s64
    v_mov_b32 v210, v14
    v_mov_b32 v211, v15
    v_lshrrev_b32 v12, 2, v2
    v_lshlrev_b32 v12, 7, v12
    v_lshl_add_u32 v12, v5, 4, v12
    s_mul_i32 s65, s2, 8448
    s_lshl_b32 s3, s17, 12
    s_add_u32 s65, s65, s3
    s_lshl_b32 s3, s16, 6
    s_add_u32 s65, s65, s3
    s_add_u32 s66, s65, 1024
    s_mov_b32 s7, 0
    s_nop 0
PL2:
    s_waitcnt vmcnt(0)
    v_cmp_ne_u64 vcc, s[60:61], v[58:59]
    s_nop 0
    s_and_b64 vcc, vcc, 0xffffffff
    s_add_u32 s7, s7, 1
    s_cmp_gt_u32 s7, 20000
    s_cselect_b64 vcc, 0, vcc
    s_cmp_eq_u64 vcc, 0
    s_nop 0
    s_cbranch_scc1 PL2D
    s_mov_b64 exec, 0xffffffff
    s_mov_b32 s6, 22036480
    buffer_load_dwordx2 v[58:59], v13, s[40:43], s6 offen offset:0 sc1
    s_mov_b64 exec, -1
    s_waitcnt vmcnt(0)
    s_nop 0
    s_branch PL2
    s_nop 0
PL2D:
    buffer_load_dwordx4 v12, s[40:43], s65 offen  lds
    buffer_load_dwordx4 v12, s[40:43], s66 offen offset:1024  lds
    s_waitcnt lgkmcnt(0)
    s_nop 0
JOIN:
    s_lshl_b32 s3, s4, 14
    v_lshl_add_u32 v214, v2, 8, s3
    s_lshl_b32 s3, s4, 12
    v_lshl_add_u32 v243, v2, 6, s3
    s_lshl_b32 s3, s4, 14
    s_add_u32 s3, s3, 128
    v_lshl_add_u32 v215, v2, 8, s3
    v_cmp_eq_u32 vcc, 3, v4
    s_nop 1
    v_addc_co_u32 v12, vcc, 0, v4, vcc
    v_mul_u32_u24 v57, 12288, v5
    v_lshl_add_u32 v57, v12, 11, v57
    s_lshl_b32 s3, s17, 4
    v_lshlrev_b32 v63, 5, v5
    v_lshl_add_u32 v63, v3, 2, v63
    v_add3_u32 v63, v63, v4, s3
    v_lshlrev_b32 v62, 5, v63
    v_lshrrev_b32 v209, 5, v2
    v_mul_u32_u24 v209, 240, v209
    v_sub_u32 v209, v62, v209
    s_lshl_b32 s3, s17, 6
    v_add_u32 v58, s3, v2
    v_add_u32 v56, v5, v3
    v_lshlrev_b32 v56, 6, v56
    v_lshl_add_u32 v56, v4, 4, v56
    v_add_u32 v7, s20, v56
    v_lshlrev_b32 v56, 5, v5
    v_lshl_add_u32 v56, v4, 3, v56
    s_lshl_b32 s3, s17, 2
    v_add3_u32 v56, v56, v3, s3
    s_add_u32 s3, s20, 192
    v_lshl_add_u32 v10, v56, 1, s3
    s_mul_i32 s21, s16, 8704
    s_add_u32 s21, s21, 16896
    v_add_u32 v56, 16, v58
    v_subrev_u32 v59, 127, v56
    v_cmp_lt_u32 vcc, 127, v56
    s_nop 1
    v_cndmask_b32 v56, v56, v59, vcc
    v_cmp_lt_u32 vcc, 123, v63
    s_nop 0
    s_mov_b64 s[22:23], vcc
    v_mov_b32 v59, 133
    v_cndmask_b32 v56, v56, v59, vcc
    v_lshl_add_u32 v8, v56, 4, s21
    v_add_u32 v56, 128, v4
    v_lshl_add_u32 v11, v56, 4, s21
    v_cmp_gt_u32 vcc, 4, v63
    s_nop 1
    v_cndmask_b32 v58, v58, v56, vcc
    v_cmp_eq_u32 vcc, 3, v4
    v_mov_b32 v59, 132
    s_nop 0
    v_cndmask_b32 v58, v58, v59, vcc
    v_lshl_add_u32 v9, v58, 4, s21
    v_mov_b32 v52, 0
    v_mov_b32 v53, 0
    v_mov_b32 v54, 0
    v_mov_b32 v55, 0
    s_and_b32 s9, s2, 1
    s_lshl_b32 s9, s9, 2
    s_bfe_u32 s3, s2, 0x20003
    s_add_u32 s9, s9, s3
    s_bfe_u32 s8, s2, 0x20001
    s_lshl_b32 s8, s8, 3
    s_lshr_b32 s3, s2, 5
    s_add_u32 s8, s8, s3
    s_lshl_b32 s13, s9, 2
    s_add_u32 s13, s13, s4
    s_lshr_b32 s14, s4, 1
    s_lshl_b32 s14, s14, 3
    s_add_u32 s14, s14, s9
    s_add_u32 s14, s14, 32
    s_and_b32 s3, s4, 1
    s_lshl_b32 s15, s14, 1
    s_add_u32 s15, s15, s3
    s_mul_i32 s10, s13, 49152
    s_add_u32 s10, s10, 16777216
    s_mov_b32 s12, s10
    s_cmp_lt_u32 s14, 43
    s_cselect_b32 s12, s12, 0x7ff00000
    v_add_u32 v240, 0x1000, v6
    v_add_u32 v241, 0x2000, v6
    v_add_u32 v242, 0x3000, v6
    v_lshlrev_b32 v56, 6, v63
    v_lshrrev_b32 v213, 1, v63
    v_lshlrev_b32 v213, 7, v213
    v_and_b32 v212, 1, v63
    v_lshl_add_u32 v213, v212, 5, v213
    s_mul_i32 s66, s2, 8448
    s_lshl_b32 s3, s16, 6
    s_add_u32 s66, s66, s3
    s_add_u32 s66, s66, 2621440
    s_mov_b32 s67, 21037056
    s_mov_b32 s69, 21045248
    s_lshl_b32 s68, s18, 2
    s_add_u32 s68, s68, 20971520
    s_add_u32 s26, s19, 5242880
    s_add_u32 s30, s19, 7864320
    s_waitcnt vmcnt(0)
    s_nop 0
B5_Y:
    s_waitcnt lgkmcnt(0)
    s_barrier
    ds_read_b128 a[64:67], v7 offset:0
    ds_read_b128 a[68:71], v7 offset:256
    ds_read_b128 a[72:75], v7 offset:512
    ds_read_b128 a[76:79], v7 offset:768
    ds_read_b128 a[80:83], v7 offset:1024
    s_waitcnt lgkmcnt(4)
    v_mfma_f32_16x16x32_bf16 v[64:67], a[0:3], a[64:67], 0
    ds_read_b128 a[84:87], v7 offset:1280
    s_waitcnt lgkmcnt(4)
    v_mfma_f32_16x16x32_bf16 v[68:71], a[0:3], a[68:71], 0
    ds_read_b128 a[88:91], v7 offset:1536
    s_nop 3
    v_mov_b32_dpp v40, v67 row_ror:12 row_mask:0xf bank_mask:0x7
    v_add_f32_dpp v64, v65, v64 row_ror:4 row_mask:0xf bank_mask:0xe
    s_nop 0
    v_add_f32_dpp v40, v66, v40 row_ror:8 row_mask:0xf bank_mask:0x3
    v_mfma_f32_16x16x32_bf16 v[68:71], a[4:7], a[64:67], v[68:71]
    v_add_f32_dpp v64, v66, v64 row_ror:8 row_mask:0xf bank_mask:0xc
    v_add_f32_dpp v40, v65, v40 row_ror:4 row_mask:0xf bank_mask:0x1
    s_nop 0
    v_add_f32_dpp v64, v67, v64 row_ror:12 row_mask:0xf bank_mask:0x8
    s_waitcnt lgkmcnt(4)
    v_mfma_f32_16x16x32_bf16 v[72:75], a[0:3], a[72:75], 0
    ds_read_b128 a[92:95], v7 offset:1792
    s_nop 0
    v_mov_b32_dpp v41, v71 row_ror:12 row_mask:0xf bank_mask:0x7
    v_add_f32_dpp v68, v69, v68 row_ror:4 row_mask:0xf bank_mask:0xe
    v_mfma_f32_16x16x32_bf16 v[72:75], a[4:7], a[68:71], v[72:75]
    v_add_f32_dpp v41, v70, v41 row_ror:8 row_mask:0xf bank_mask:0x3
    v_add_f32_dpp v68, v70, v68 row_ror:8 row_mask:0xf bank_mask:0xc
    s_nop 0
    v_add_f32_dpp v41, v69, v41 row_ror:4 row_mask:0xf bank_mask:0x1
    v_mfma_f32_16x16x32_bf16 v[72:75], a[8:11], a[64:67], v[72:75]
    v_add_f32_dpp v68, v71, v68 row_ror:12 row_mask:0xf bank_mask:0x8
    s_waitcnt lgkmcnt(4)
    v_mfma_f32_16x16x32_bf16 v[76:79], a[0:3], a[76:79], 0
    ds_read_b128 a[96:99], v7 offset:2048
    s_nop 3
    v_mov_b32_dpp v42, v75 row_ror:12 row_mask:0xf bank_mask:0x7
    v_mfma_f32_16x16x32_bf16 v[76:79], a[4:7], a[72:75], v[76:79]
    v_add_f32_dpp v72, v73, v72 row_ror:4 row_mask:0xf bank_mask:0xe
    v_add_f32_dpp v42, v74, v42 row_ror:8 row_mask:0xf bank_mask:0x3
    v_mfma_f32_16x16x32_bf16 v[76:79], a[8:11], a[68:71], v[76:79]
    v_add_f32_dpp v72, v74, v72 row_ror:8 row_mask:0xf bank_mask:0xc
    v_add_f32_dpp v42, v73, v42 row_ror:4 row_mask:0xf bank_mask:0x1
    v_mfma_f32_16x16x32_bf16 v[76:79], a[12:15], a[64:67], v[76:79]
    v_add_f32_dpp v72, v75, v72 row_ror:12 row_mask:0xf bank_mask:0x8
    s_waitcnt lgkmcnt(4)
    v_mfma_f32_16x16x32_bf16 v[80:83], a[0:3], a[80:83], 0
    ds_read_b128 a[100:103], v7 offset:2304
    s_nop 3
    v_mov_b32_dpp v43, v79 row_ror:12 row_mask:0xf bank_mask:0x7
    v_add_f32_dpp v76, v77, v76 row_ror:4 row_mask:0xf bank_mask:0xe
    v_mfma_f32_16x16x32_bf16 v[80:83], a[4:7], a[76:79], v[80:83]
    v_add_f32_dpp v43, v78, v43 row_ror:8 row_mask:0xf bank_mask:0x3
    v_add_f32_dpp v76, v78, v76 row_ror:8 row_mask:0xf bank_mask:0xc
    s_nop 0
    v_add_f32_dpp v43, v77, v43 row_ror:4 row_mask:0xf bank_mask:0x1
    v_mfma_f32_16x16x32_bf16 v[80:83], a[8:11], a[72:75], v[80:83]
    v_add_f32_dpp v76, v79, v76 row_ror:12 row_mask:0xf bank_mask:0x8
    ds_write_b128 v8, v[40:43] offset:0
    s_mov_b64 exec, s[22:23]
    ds_write_b32 v11, v40 offset:4
    ds_write_b32 v11, v41 offset:8
    ds_write_b32 v11, v42 offset:12
    ds_write_b32 v11, v43 offset:2176
    s_mov_b64 exec, -1
    v_mfma_f32_16x16x32_bf16 v[80:83], a[12:15], a[68:71], v[80:83]
    s_waitcnt vmcnt(0)
    s_waitcnt lgkmcnt(0)
    s_barrier
    s_cmp_lg_u32 s4, 0
    s_nop 3
    s_cbranch_scc1 SF3
    s_lshl_b32 s3, s2, 6
    s_add_u32 s3, s3, 22052864
    v_mov_b32 v216, s60
    v_mov_b32 v217, s61
    v_mov_b32 v218, 0
    s_mov_b64 exec, 1
    buffer_store_dwordx2 v[216:217], v218, s[40:43], s3 offen sc1
    s_mov_b64 exec, -1
    s_nop 1
SF3:
    v_mfma_f32_16x16x32_bf16 v[80:83], a[16:19], a[64:67], v[80:83]
    v_mfma_f32_16x16x32_bf16 v[84:87], a[0:3], a[84:87], 0
    ds_read_b128 a[104:107], v7 offset:2560
    s_nop 5
    v_mov_b32_dpp v44, v83 row_ror:12 row_mask:0xf bank_mask:0x7
    v_mfma_f32_16x16x32_bf16 v[84:87], a[4:7], a[80:83], v[84:87]
    v_add_f32_dpp v80, v81, v80 row_ror:4 row_mask:0xf bank_mask:0xe
    v_add_f32_dpp v44, v82, v44 row_ror:8 row_mask:0xf bank_mask:0x3
    v_mfma_f32_16x16x32_bf16 v[84:87], a[8:11], a[76:79], v[84:87]
    v_add_f32_dpp v80, v82, v80 row_ror:8 row_mask:0xf bank_mask:0xc
    v_add_f32_dpp v44, v81, v44 row_ror:4 row_mask:0xf bank_mask:0x1
    v_mfma_f32_16x16x32_bf16 v[84:87], a[12:15], a[72:75], v[84:87]
    v_add_f32_dpp v80, v83, v80 row_ror:12 row_mask:0xf bank_mask:0x8
    v_mfma_f32_16x16x32_bf16 v[84:87], a[16:19], a[68:71], v[84:87]
    v_mfma_f32_16x16x32_bf16 v[84:87], a[20:23], a[64:67], v[84:87]
    v_mfma_f32_16x16x32_bf16 v[88:91], a[0:3], a[88:91], 0
    ds_read_b128 a[108:111], v7 offset:2816
    s_nop 5
    v_mov_b32_dpp v45, v87 row_ror:12 row_mask:0xf bank_mask:0x7
    v_mfma_f32_16x16x32_bf16 v[88:91], a[4:7], a[84:87], v[88:91]
    v_add_f32_dpp v84, v85, v84 row_ror:4 row_mask:0xf bank_mask:0xe
    v_add_f32_dpp v45, v86, v45 row_ror:8 row_mask:0xf bank_mask:0x3
    v_mfma_f32_16x16x32_bf16 v[88:91], a[8:11], a[80:83], v[88:91]
    v_add_f32_dpp v84, v86, v84 row_ror:8 row_mask:0xf bank_mask:0xc
    v_add_f32_dpp v45, v85, v45 row_ror:4 row_mask:0xf bank_mask:0x1
    v_mfma_f32_16x16x32_bf16 v[88:91], a[12:15], a[76:79], v[88:91]
    v_add_f32_dpp v84, v87, v84 row_ror:12 row_mask:0xf bank_mask:0x8
    s_mov_b32 s6, 22102016
    buffer_load_dwordx2 v[24:25], v214, s[40:43], s6 offen offset:0 sc1
    buffer_load_dwordx2 v[26:27], v214, s[40:43], s6 offen offset:64 sc1
    v_mfma_f32_16x16x32_bf16 v[88:91], a[16:19], a[72:75], v[88:91]
    v_mfma_f32_16x16x32_bf16 v[88:91], a[20:23], a[68:71], v[88:91]
    v_mfma_f32_16x16x32_bf16 v[88:91], a[24:27], a[64:67], v[88:91]
    v_mfma_f32_16x16x32_bf16 v[92:95], a[0:3], a[92:95], 0
    ds_read_b128 a[112:115], v7 offset:3072
    v_mfma_f32_16x16x32_bf16 v[92:95], a[4:7], a[88:91], v[92:95]
    s_nop 4
    v_mov_b32_dpp v46, v91 row_ror:12 row_mask:0xf bank_mask:0x7
    v_mfma_f32_16x16x32_bf16 v[92:95], a[8:11], a[84:87], v[92:95]
    v_add_f32_dpp v88, v89, v88 row_ror:4 row_mask:0xf bank_mask:0xe
    v_mfma_f32_16x16x32_bf16 v[92:95], a[12:15], a[80:83], v[92:95]
    v_add_f32_dpp v46, v90, v46 row_ror:8 row_mask:0xf bank_mask:0x3
    v_mfma_f32_16x16x32_bf16 v[92:95], a[16:19], a[76:79], v[92:95]
    v_add_f32_dpp v88, v90, v88 row_ror:8 row_mask:0xf bank_mask:0xc
    v_mfma_f32_16x16x32_bf16 v[92:95], a[20:23], a[72:75], v[92:95]
    v_add_f32_dpp v46, v89, v46 row_ror:4 row_mask:0xf bank_mask:0x1
    v_mfma_f32_16x16x32_bf16 v[92:95], a[24:27], a[68:71], v[92:95]
    v_add_f32_dpp v88, v91, v88 row_ror:12 row_mask:0xf bank_mask:0x8
    v_mfma_f32_16x16x32_bf16 v[92:95], a[28:31], a[64:67], v[92:95]
    v_mfma_f32_16x16x32_bf16 v[96:99], a[0:3], a[96:99], 0
    ds_read_b128 a[116:119], v7 offset:3328
    s_nop 5
    v_mov_b32_dpp v47, v95 row_ror:12 row_mask:0xf bank_mask:0x7
    v_mfma_f32_16x16x32_bf16 v[96:99], a[4:7], a[92:95], v[96:99]
    v_add_f32_dpp v92, v93, v92 row_ror:4 row_mask:0xf bank_mask:0xe
    v_add_f32_dpp v47, v94, v47 row_ror:8 row_mask:0xf bank_mask:0x3
    v_mfma_f32_16x16x32_bf16 v[96:99], a[8:11], a[88:91], v[96:99]
    v_add_f32_dpp v92, v94, v92 row_ror:8 row_mask:0xf bank_mask:0xc
    v_add_f32_dpp v47, v93, v47 row_ror:4 row_mask:0xf bank_mask:0x1
    v_mfma_f32_16x16x32_bf16 v[96:99], a[12:15], a[84:87], v[96:99]
    v_add_f32_dpp v92, v95, v92 row_ror:12 row_mask:0xf bank_mask:0x8
    s_mov_b32 s7, 0
    s_nop 5
PL4:
    s_waitcnt vmcnt(1)
    v_cmp_ne_u64 vcc, s[60:61], v[24:25]
    s_waitcnt vmcnt(0)
    v_cmp_ne_u64 s[70:71], s[60:61], v[26:27]
    s_nop 0
    s_or_b64 vcc, vcc, s[70:71]
    s_add_u32 s7, s7, 1
    s_cmp_gt_u32 s7, 20000
    s_cselect_b64 vcc, 0, vcc
    s_cmp_eq_u64 vcc, 0
    s_nop 0
    s_cbranch_scc1 PL4D
    s_mov_b32 s6, 22102016
    buffer_load_dwordx2 v[24:25], v214, s[40:43], s6 offen offset:0 sc1
    buffer_load_dwordx2 v[26:27], v214, s[40:43], s6 offen offset:64 sc1
    s_waitcnt vmcnt(0)
    s_nop 0
    s_branch PL4
    s_nop 0
PL4D:
    v_mfma_f32_16x16x32_bf16 v[96:99], a[16:19], a[80:83], v[96:99]
    ds_write_b128 v8, v[44:47] offset:2176
    s_mov_b64 exec, s[22:23]
    ds_write_b32 v11, v44 offset:2180
    ds_write_b32 v11, v45 offset:2184
    ds_write_b32 v11, v46 offset:2188
    ds_write_b32 v11, v47 offset:4352
    s_mov_b64 exec, -1
    v_mfma_f32_16x16x32_bf16 v[96:99], a[20:23], a[76:79], v[96:99]
    s_waitcnt lgkmcnt(0)
    s_barrier
    buffer_load_dword v58, v57, s[40:43], s68 offen
    v_mfma_f32_16x16x32_bf16 v[96:99], a[24:27], a[72:75], v[96:99]
    buffer_load_dwordx4 v[16:19], v213, s[40:43], s66 offen
    buffer_load_dwordx4 v[24:27], v56, s[40:43], s67 offen offset:0
    v_mfma_f32_16x16x32_bf16 v[96:99], a[28:31], a[68:71], v[96:99]
    buffer_load_dwordx4 v[192:195], v56, s[40:43], s69 offen offset:0
    buffer_load_dwordx4 v[28:31], v56, s[40:43], s67 offen offset:16
    v_mfma_f32_16x16x32_bf16 v[96:99], a[32:35], a[64:67], v[96:99]
    buffer_load_dwordx4 v[196:199], v56, s[40:43], s69 offen offset:16
    v_mfma_f32_16x16x32_bf16 v[100:103], a[0:3], a[100:103], 0
    ds_read_b128 a[120:123], v7 offset:3584
    s_nop 4
    v_mov_b32_dpp v40, v99 row_ror:12 row_mask:0xf bank_mask:0x7
    v_mfma_f32_16x16x32_bf16 v[100:103], a[4:7], a[96:99], v[100:103]
    v_add_f32_dpp v96, v97, v96 row_ror:4 row_mask:0xf bank_mask:0xe
    v_add_f32_dpp v40, v98, v40 row_ror:8 row_mask:0xf bank_mask:0x3
    v_mfma_f32_16x16x32_bf16 v[100:103], a[8:11], a[92:95], v[100:103]
    v_add_f32_dpp v96, v98, v96 row_ror:8 row_mask:0xf bank_mask:0xc
    v_add_f32_dpp v40, v97, v40 row_ror:4 row_mask:0xf bank_mask:0x1
    v_mfma_f32_16x16x32_bf16 v[100:103], a[12:15], a[88:91], v[100:103]
    v_add_f32_dpp v96, v99, v96 row_ror:12 row_mask:0xf bank_mask:0x8
    buffer_load_dwordx4 v[20:23], v213, s[40:43], s66 offen offset:16
    v_mfma_f32_16x16x32_bf16 v[100:103], a[16:19], a[84:87], v[100:103]
    buffer_load_dwordx4 v[32:35], v56, s[40:43], s67 offen offset:32
    buffer_load_dwordx4 v[200:203], v56, s[40:43], s69 offen offset:32
    v_mfma_f32_16x16x32_bf16 v[100:103], a[20:23], a[80:83], v[100:103]
    buffer_load_dwordx4 v[36:39], v56, s[40:43], s67 offen offset:48
    buffer_load_dwordx4 v[204:207], v56, s[40:43], s69 offen offset:48
    v_mfma_f32_16x16x32_bf16 v[100:103], a[24:27], a[76:79], v[100:103]
    v_mfma_f32_16x16x32_bf16 v[100:103], a[28:31], a[72:75], v[100:103]
    v_mfma_f32_16x16x32_bf16 v[100:103], a[32:35], a[68:71], v[100:103]
    v_mfma_f32_16x16x32_bf16 v[100:103], a[36:39], a[64:67], v[100:103]
    v_mfma_f32_16x16x32_bf16 v[104:107], a[0:3], a[104:107], 0
    ds_read_b128 a[124:127], v7 offset:3840
    v_mfma_f32_16x16x32_bf16 v[104:107], a[4:7], a[100:103], v[104:107]
    s_nop 4
    v_mov_b32_dpp v41, v103 row_ror:12 row_mask:0xf bank_mask:0x7
    v_mfma_f32_16x16x32_bf16 v[104:107], a[8:11], a[96:99], v[104:107]
    v_add_f32_dpp v100, v101, v100 row_ror:4 row_mask:0xf bank_mask:0xe
    v_mfma_f32_16x16x32_bf16 v[104:107], a[12:15], a[92:95], v[104:107]
    v_add_f32_dpp v41, v102, v41 row_ror:8 row_mask:0xf bank_mask:0x3
    v_mfma_f32_16x16x32_bf16 v[104:107], a[16:19], a[88:91], v[104:107]
    v_add_f32_dpp v100, v102, v100 row_ror:8 row_mask:0xf bank_mask:0xc
    v_mfma_f32_16x16x32_bf16 v[104:107], a[20:23], a[84:87], v[104:107]
    v_add_f32_dpp v41, v101, v41 row_ror:4 row_mask:0xf bank_mask:0x1
    v_mfma_f32_16x16x32_bf16 v[104:107], a[24:27], a[80:83], v[104:107]
    v_add_f32_dpp v100, v103, v100 row_ror:12 row_mask:0xf bank_mask:0x8
    v_mfma_f32_16x16x32_bf16 v[104:107], a[28:31], a[76:79], v[104:107]
    v_mfma_f32_16x16x32_bf16 v[104:107], a[32:35], a[72:75], v[104:107]
    v_mfma_f32_16x16x32_bf16 v[104:107], a[36:39], a[68:71], v[104:107]
    v_mfma_f32_16x16x32_bf16 v[104:107], a[40:43], a[64:67], v[104:107]
    v_mfma_f32_16x16x32_bf16 v[108:111], a[0:3], a[108:111], 0
    s_nop 6
    v_mov_b32_dpp v42, v107 row_ror:12 row_mask:0xf bank_mask:0x7
    v_mfma_f32_16x16x32_bf16 v[108:111], a[4:7], a[104:107], v[108:111]
    v_add_f32_dpp v104, v105, v104 row_ror:4 row_mask:0xf bank_mask:0xe
    v_mfma_f32_16x16x32_bf16 v[108:111], a[8:11], a[100:103], v[108:111]
    v_add_f32_dpp v42, v106, v42 row_ror:8 row_mask:0xf bank_mask:0x3
    v_mfma_f32_16x16x32_bf16 v[108:111], a[12:15], a[96:99], v[108:111]
    v_add_f32_dpp v104, v106, v104 row_ror:8 row_mask:0xf bank_mask:0xc
    v_mfma_f32_16x16x32_bf16 v[108:111], a[16:19], a[92:95], v[108:111]
    v_add_f32_dpp v42, v105, v42 row_ror:4 row_mask:0xf bank_mask:0x1
    v_mfma_f32_16x16x32_bf16 v[108:111], a[20:23], a[88:91], v[108:111]
    v_add_f32_dpp v104, v107, v104 row_ror:12 row_mask:0xf bank_mask:0x8
    v_mfma_f32_16x16x32_bf16 v[108:111], a[24:27], a[84:87], v[108:111]
    v_mfma_f32_16x16x32_bf16 v[108:111], a[28:31], a[80:83], v[108:111]
    v_mfma_f32_16x16x32_bf16 v[108:111], a[32:35], a[76:79], v[108:111]
    v_mfma_f32_16x16x32_bf16 v[108:111], a[36:39], a[72:75], v[108:111]
    v_mfma_f32_16x16x32_bf16 v[108:111], a[40:43], a[68:71], v[108:111]
    v_mfma_f32_16x16x32_bf16 v[108:111], a[44:47], a[64:67], v[108:111]
    v_mfma_f32_16x16x32_bf16 v[112:115], a[0:3], a[112:115], 0
    s_nop 6
    v_mov_b32_dpp v43, v111 row_ror:12 row_mask:0xf bank_mask:0x7
    v_mfma_f32_16x16x32_bf16 v[112:115], a[4:7], a[108:111], v[112:115]
    v_add_f32_dpp v108, v109, v108 row_ror:4 row_mask:0xf bank_mask:0xe
    v_mfma_f32_16x16x32_bf16 v[112:115], a[8:11], a[104:107], v[112:115]
    v_add_f32_dpp v43, v110, v43 row_ror:8 row_mask:0xf bank_mask:0x3
    v_mfma_f32_16x16x32_bf16 v[112:115], a[12:15], a[100:103], v[112:115]
    v_add_f32_dpp v108, v110, v108 row_ror:8 row_mask:0xf bank_mask:0xc
    v_mfma_f32_16x16x32_bf16 v[112:115], a[16:19], a[96:99], v[112:115]
    v_add_f32_dpp v43, v109, v43 row_ror:4 row_mask:0xf bank_mask:0x1
    v_mfma_f32_16x16x32_bf16 v[112:115], a[20:23], a[92:95], v[112:115]
    v_add_f32_dpp v108, v111, v108 row_ror:12 row_mask:0xf bank_mask:0x8
    v_mfma_f32_16x16x32_bf16 v[112:115], a[24:27], a[88:91], v[112:115]
    ds_write_b128 v8, v[40:43] offset:4352
    v_mfma_f32_16x16x32_bf16 v[112:115], a[28:31], a[84:87], v[112:115]
    s_mov_b64 exec, s[22:23]
    ds_write_b32 v11, v40 offset:4356
    ds_write_b32 v11, v41 offset:4360
    ds_write_b32 v11, v42 offset:4364
    ds_write_b32 v11, v43 offset:6528
    s_mov_b64 exec, -1
    v_mfma_f32_16x16x32_bf16 v[112:115], a[32:35], a[80:83], v[112:115]
    s_waitcnt lgkmcnt(0)
    s_barrier
    v_mfma_f32_16x16x32_bf16 v[112:115], a[36:39], a[76:79], v[112:115]
    v_mfma_f32_16x16x32_bf16 v[112:115], a[40:43], a[72:75], v[112:115]
    v_mfma_f32_16x16x32_bf16 v[112:115], a[44:47], a[68:71], v[112:115]
    v_mfma_f32_16x16x32_bf16 v[112:115], a[48:51], a[64:67], v[112:115]
    v_mfma_f32_16x16x32_bf16 v[116:119], a[0:3], a[116:119], 0
    s_nop 6
    v_mov_b32_dpp v44, v115 row_ror:12 row_mask:0xf bank_mask:0x7
    v_mfma_f32_16x16x32_bf16 v[116:119], a[4:7], a[112:115], v[116:119]
    v_add_f32_dpp v112, v113, v112 row_ror:4 row_mask:0xf bank_mask:0xe
    v_mfma_f32_16x16x32_bf16 v[116:119], a[8:11], a[108:111], v[116:119]
    v_add_f32_dpp v44, v114, v44 row_ror:8 row_mask:0xf bank_mask:0x3
    v_mfma_f32_16x16x32_bf16 v[116:119], a[12:15], a[104:107], v[116:119]
    v_add_f32_dpp v112, v114, v112 row_ror:8 row_mask:0xf bank_mask:0xc
    v_mfma_f32_16x16x32_bf16 v[116:119], a[16:19], a[100:103], v[116:119]
    v_add_f32_dpp v44, v113, v44 row_ror:4 row_mask:0xf bank_mask:0x1
    v_mfma_f32_16x16x32_bf16 v[116:119], a[20:23], a[96:99], v[116:119]
    v_add_f32_dpp v112, v115, v112 row_ror:12 row_mask:0xf bank_mask:0x8
    v_mfma_f32_16x16x32_bf16 v[116:119], a[24:27], a[92:95], v[116:119]
    v_mfma_f32_16x16x32_bf16 v[116:119], a[28:31], a[88:91], v[116:119]
    v_mfma_f32_16x16x32_bf16 v[116:119], a[32:35], a[84:87], v[116:119]
    v_mfma_f32_16x16x32_bf16 v[116:119], a[36:39], a[80:83], v[116:119]
    v_mfma_f32_16x16x32_bf16 v[116:119], a[40:43], a[76:79], v[116:119]
    v_mfma_f32_16x16x32_bf16 v[116:119], a[44:47], a[72:75], v[116:119]
    v_mfma_f32_16x16x32_bf16 v[116:119], a[48:51], a[68:71], v[116:119]
    v_mfma_f32_16x16x32_bf16 v[116:119], a[52:55], a[64:67], v[116:119]
    v_mfma_f32_16x16x32_bf16 v[120:123], a[0:3], a[120:123], 0
    s_nop 6
    v_mov_b32_dpp v45, v119 row_ror:12 row_mask:0xf bank_mask:0x7
    v_mfma_f32_16x16x32_bf16 v[120:123], a[4:7], a[116:119], v[120:123]
    v_add_f32_dpp v116, v117, v116 row_ror:4 row_mask:0xf bank_mask:0xe
    v_mfma_f32_16x16x32_bf16 v[120:123], a[8:11], a[112:115], v[120:123]
    v_add_f32_dpp v45, v118, v45 row_ror:8 row_mask:0xf bank_mask:0x3
    v_mfma_f32_16x16x32_bf16 v[120:123], a[12:15], a[108:111], v[120:123]
    v_add_f32_dpp v116, v118, v116 row_ror:8 row_mask:0xf bank_mask:0xc
    v_mfma_f32_16x16x32_bf16 v[120:123], a[16:19], a[104:107], v[120:123]
    v_add_f32_dpp v45, v117, v45 row_ror:4 row_mask:0xf bank_mask:0x1
    v_mfma_f32_16x16x32_bf16 v[120:123], a[20:23], a[100:103], v[120:123]
    v_add_f32_dpp v116, v119, v116 row_ror:12 row_mask:0xf bank_mask:0x8
    v_mfma_f32_16x16x32_bf16 v[120:123], a[24:27], a[96:99], v[120:123]
    s_mov_b32 s6, 22052864
    buffer_load_dwordx2 v[252:253], v243, s[40:43], s6 offen offset:0 sc1
    v_mfma_f32_16x16x32_bf16 v[120:123], a[28:31], a[92:95], v[120:123]
    v_mfma_f32_16x16x32_bf16 v[120:123], a[32:35], a[88:91], v[120:123]
    v_mfma_f32_16x16x32_bf16 v[120:123], a[36:39], a[84:87], v[120:123]
    v_mfma_f32_16x16x32_bf16 v[120:123], a[40:43], a[80:83], v[120:123]
    v_mfma_f32_16x16x32_bf16 v[120:123], a[44:47], a[76:79], v[120:123]
    v_mfma_f32_16x16x32_bf16 v[120:123], a[48:51], a[72:75], v[120:123]
    v_mfma_f32_16x16x32_bf16 v[120:123], a[52:55], a[68:71], v[120:123]
    v_mfma_f32_16x16x32_bf16 v[120:123], a[56:59], a[64:67], v[120:123]
    v_mfma_f32_16x16x32_bf16 v[124:127], a[0:3], a[124:127], 0
    s_nop 6
    v_mov_b32_dpp v46, v123 row_ror:12 row_mask:0xf bank_mask:0x7
    v_mfma_f32_16x16x32_bf16 v[124:127], a[4:7], a[120:123], v[124:127]
    v_add_f32_dpp v120, v121, v120 row_ror:4 row_mask:0xf bank_mask:0xe
    v_mfma_f32_16x16x32_bf16 v[124:127], a[8:11], a[116:119], v[124:127]
    v_add_f32_dpp v46, v122, v46 row_ror:8 row_mask:0xf bank_mask:0x3
    v_mfma_f32_16x16x32_bf16 v[124:127], a[12:15], a[112:115], v[124:127]
    v_add_f32_dpp v120, v122, v120 row_ror:8 row_mask:0xf bank_mask:0xc
    v_mfma_f32_16x16x32_bf16 v[124:127], a[16:19], a[108:111], v[124:127]
    v_add_f32_dpp v46, v121, v46 row_ror:4 row_mask:0xf bank_mask:0x1
    v_mfma_f32_16x16x32_bf16 v[124:127], a[20:23], a[104:107], v[124:127]
    v_add_f32_dpp v120, v123, v120 row_ror:12 row_mask:0xf bank_mask:0x8
    v_mfma_f32_16x16x32_bf16 v[124:127], a[24:27], a[100:103], v[124:127]
    v_mfma_f32_16x16x32_bf16 v[124:127], a[28:31], a[96:99], v[124:127]
    v_mfma_f32_16x16x32_bf16 v[124:127], a[32:35], a[92:95], v[124:127]
    v_mfma_f32_16x16x32_bf16 v[124:127], a[36:39], a[88:91], v[124:127]
    v_mfma_f32_16x16x32_bf16 v[124:127], a[40:43], a[84:87], v[124:127]
    v_mfma_f32_16x16x32_bf16 v[124:127], a[44:47], a[80:83], v[124:127]
    v_mfma_f32_16x16x32_bf16 v[124:127], a[48:51], a[76:79], v[124:127]
    v_mfma_f32_16x16x32_bf16 v[124:127], a[52:55], a[72:75], v[124:127]
    v_mfma_f32_16x16x32_bf16 v[124:127], a[56:59], a[68:71], v[124:127]
    v_mfma_f32_16x16x32_bf16 v[124:127], a[60:63], a[64:67], v[124:127]
    s_waitcnt vmcnt(11)
    v_add_f32_dpp v58, v58, v58 quad_perm:[1,0,3,2] row_mask:0xf bank_mask:0xf
    s_nop 1
    v_add_f32_dpp v58, v58, v58 quad_perm:[2,3,0,1] row_mask:0xf bank_mask:0xf
    v_cvt_pk_bf16_f32 v58, 0, v58
    v_add_f32 v59, 1.0, v58
    v_cvt_pk_bf16_f32 v59, 0, v59
    v_readlane_b32 s64, v58, 0
    v_readlane_b32 s65, v59, 4
    v_readlane_b32 s66, v58, 8
    v_readlane_b32 s67, v59, 12
    v_mov_b32 v14, s64
    v_mov_b32 v13, s65
    v_mov_b32 v15, s66
    v_mov_b32 v208, s67
    s_lshl_b32 s64, s81, 16
    s_and_b32 s65, s81, s5
    s_cmp_eq_u32 s16, 0
    s_cselect_b32 s64, s64, s65
    v_mov_b32 v12, s64
    ds_read_u16_d16_hi v52, v10 offset:0
    ds_read_u16_d16_hi v53, v10 offset:256
    ds_read_u16_d16_hi v54, v10 offset:512
    ds_read_u16_d16_hi v55, v10 offset:768
    ds_read_b128 v[48:51], v9 offset:0
    s_waitcnt vmcnt(10)
    v_lshlrev_b32 v60, 16, v16
    v_mov_b32_dpp v47, v127 row_ror:12 row_mask:0xf bank_mask:0x7
    v_lshlrev_b32 v216, 16, v17
    v_add_f32_dpp v124, v125, v124 row_ror:4 row_mask:0xf bank_mask:0xe
    v_lshlrev_b32 v218, 16, v18
    v_add_f32_dpp v47, v126, v47 row_ror:8 row_mask:0xf bank_mask:0x3
    v_lshlrev_b32 v220, 16, v19
    v_add_f32_dpp v124, v126, v124 row_ror:8 row_mask:0xf bank_mask:0xc
    v_and_b32 v61, s5, v16
    v_add_f32_dpp v47, v125, v47 row_ror:4 row_mask:0xf bank_mask:0x1
    v_and_b32 v217, s5, v17
    v_add_f32_dpp v124, v127, v124 row_ror:12 row_mask:0xf bank_mask:0x8
    v_and_b32 v219, s5, v18
    v_and_b32 v221, s5, v19
    s_waitcnt vmcnt(9)
    v_pk_add_f32 v[24:25], v[60:61], v[24:25] neg_lo:[0,1] neg_hi:[0,1]
    v_pk_add_f32 v[26:27], v[216:217], v[26:27] neg_lo:[0,1] neg_hi:[0,1]
    s_waitcnt vmcnt(7)
    v_pk_add_f32 v[28:29], v[218:219], v[28:29] neg_lo:[0,1] neg_hi:[0,1]
    v_pk_add_f32 v[30:31], v[220:221], v[30:31] neg_lo:[0,1] neg_hi:[0,1]
    v_pk_mul_f32 v[24:25], v[24:25], v[192:193]
    v_pk_mul_f32 v[26:27], v[26:27], v[194:195]
    s_waitcnt vmcnt(6)
    v_pk_mul_f32 v[28:29], v[28:29], v[196:197]
    v_pk_mul_f32 v[30:31], v[30:31], v[198:199]
    v_pk_fma_f32 v[24:25], v[24:25], v[12:13], v[14:15] op_sel:[0,1,0] op_sel_hi:[1,1,0]
    v_pk_fma_f32 v[26:27], v[26:27], v[12:13], v[14:15] op_sel:[0,1,0] op_sel_hi:[1,1,0]
    v_pk_fma_f32 v[28:29], v[28:29], v[12:13], v[14:15] op_sel:[0,1,0] op_sel_hi:[1,1,0]
    v_pk_fma_f32 v[30:31], v[30:31], v[12:13], v[14:15] op_sel:[0,1,0] op_sel_hi:[1,1,0]
    v_pk_mul_f32 v[24:25], v[24:25], v[14:15] op_sel:[0,1] op_sel_hi:[1,1]
    v_pk_mul_f32 v[26:27], v[26:27], v[14:15] op_sel:[0,1] op_sel_hi:[1,1]
    v_pk_mul_f32 v[28:29], v[28:29], v[14:15] op_sel:[0,1] op_sel_hi:[1,1]
    v_pk_mul_f32 v[30:31], v[30:31], v[14:15] op_sel:[0,1] op_sel_hi:[1,1]
    ds_write_b128 v8, v[44:47] offset:6528
    s_mov_b64 exec, s[22:23]
    ds_write_b32 v11, v44 offset:6532
    ds_write_b32 v11, v45 offset:6536
    ds_write_b32 v11, v46 offset:6540
    s_mov_b64 exec, -1
    s_waitcnt lgkmcnt(4)
    v_pk_fma_f32 v[48:49], v[52:53], v[12:13], v[48:49] op_sel:[0,0,0] op_sel_hi:[1,0,1]
    v_pk_fma_f32 v[50:51], v[54:55], v[12:13], v[50:51] op_sel:[0,0,0] op_sel_hi:[1,0,1]
    v_lshlrev_b32 v60, 16, v16
    v_lshlrev_b32 v216, 16, v17
    v_and_b32 v61, s5, v16
    v_and_b32 v217, s5, v17
    v_add_f32 v48, v64, v48
    v_add_f32 v50, v72, v50
    v_add_f32 v49, v68, v49
    v_add_f32 v51, v76, v51
    v_pk_fma_f32 v[48:49], v[24:25], v[48:49], v[60:61]
    v_pk_fma_f32 v[50:51], v[26:27], v[50:51], v[216:217]
    v_cvt_pk_bf16_f32 v16, v48, v49
    v_cvt_pk_bf16_f32 v17, v50, v51
    v_pk_mul_f32 v[48:49], v[48:49], v[208:209] op_sel:[0,0] op_sel_hi:[1,0]
    v_pk_mul_f32 v[50:51], v[50:51], v[208:209] op_sel:[0,0] op_sel_hi:[1,0]
    v_cvt_pk_bf16_f32 v24, v48, v49
    v_cvt_pk_bf16_f32 v25, v50, v51
    ds_read_u16_d16_hi v52, v10 offset:1024
    ds_read_u16_d16_hi v53, v10 offset:1280
    ds_read_u16_d16_hi v54, v10 offset:1536
    ds_read_u16_d16_hi v55, v10 offset:1792
    ds_read_b128 v[48:51], v9 offset:2176
    s_waitcnt vmcnt(5)
    v_lshlrev_b32 v60, 16, v20
    v_lshlrev_b32 v216, 16, v21
    v_lshlrev_b32 v218, 16, v22
    v_lshlrev_b32 v220, 16, v23
    v_and_b32 v61, s5, v20
    v_and_b32 v217, s5, v21
    v_and_b32 v219, s5, v22
    v_and_b32 v221, s5, v23
    s_waitcnt vmcnt(4)
    v_pk_add_f32 v[32:33], v[60:61], v[32:33] neg_lo:[0,1] neg_hi:[0,1]
    v_pk_add_f32 v[34:35], v[216:217], v[34:35] neg_lo:[0,1] neg_hi:[0,1]
    s_waitcnt vmcnt(2)
    v_pk_add_f32 v[36:37], v[218:219], v[36:37] neg_lo:[0,1] neg_hi:[0,1]
    v_pk_add_f32 v[38:39], v[220:221], v[38:39] neg_lo:[0,1] neg_hi:[0,1]
    v_pk_mul_f32 v[32:33], v[32:33], v[200:201]
    v_pk_mul_f32 v[34:35], v[34:35], v[202:203]
    s_waitcnt lgkmcnt(0)
    v_pk_fma_f32 v[48:49], v[52:53], v[12:13], v[48:49] op_sel:[0,0,0] op_sel_hi:[1,0,1]
    v_pk_fma_f32 v[50:51], v[54:55], v[12:13], v[50:51] op_sel:[0,0,0] op_sel_hi:[1,0,1]
    v_lshlrev_b32 v60, 16, v18
    v_lshlrev_b32 v216, 16, v19
    v_and_b32 v61, s5, v18
    v_and_b32 v217, s5, v19
    v_add_f32 v48, v80, v48
    v_add_f32 v50, v88, v50
    v_add_f32 v49, v84, v49
    v_add_f32 v51, v92, v51
    v_pk_fma_f32 v[48:49], v[28:29], v[48:49], v[60:61]
    v_pk_fma_f32 v[50:51], v[30:31], v[50:51], v[216:217]
    v_cvt_pk_bf16_f32 v18, v48, v49
    v_cvt_pk_bf16_f32 v19, v50, v51
    v_pk_mul_f32 v[48:49], v[48:49], v[208:209] op_sel:[0,0] op_sel_hi:[1,0]
    v_pk_mul_f32 v[50:51], v[50:51], v[208:209] op_sel:[0,0] op_sel_hi:[1,0]
    v_cvt_pk_bf16_f32 v26, v48, v49
    v_cvt_pk_bf16_f32 v27, v50, v51
    ds_read_u16_d16_hi v52, v10 offset:2048
    ds_read_u16_d16_hi v53, v10 offset:2304
    ds_read_u16_d16_hi v54, v10 offset:2560
    ds_read_u16_d16_hi v55, v10 offset:2816
    ds_read_b128 v[48:51], v9 offset:4352
    s_waitcnt vmcnt(1)
    v_pk_mul_f32 v[36:37], v[36:37], v[204:205]
    v_pk_mul_f32 v[38:39], v[38:39], v[206:207]
    v_pk_fma_f32 v[32:33], v[32:33], v[12:13], v[14:15] op_sel:[0,1,0] op_sel_hi:[1,1,0]
    v_pk_fma_f32 v[34:35], v[34:35], v[12:13], v[14:15] op_sel:[0,1,0] op_sel_hi:[1,1,0]
    v_pk_fma_f32 v[36:37], v[36:37], v[12:13], v[14:15] op_sel:[0,1,0] op_sel_hi:[1,1,0]
    v_pk_fma_f32 v[38:39], v[38:39], v[12:13], v[14:15] op_sel:[0,1,0] op_sel_hi:[1,1,0]
    v_pk_mul_f32 v[32:33], v[32:33], v[14:15] op_sel:[0,1] op_sel_hi:[1,1]
    v_pk_mul_f32 v[34:35], v[34:35], v[14:15] op_sel:[0,1] op_sel_hi:[1,1]
    v_pk_mul_f32 v[36:37], v[36:37], v[14:15] op_sel:[0,1] op_sel_hi:[1,1]
    v_pk_mul_f32 v[38:39], v[38:39], v[14:15] op_sel:[0,1] op_sel_hi:[1,1]
    s_waitcnt lgkmcnt(0)
    s_barrier
    v_pk_fma_f32 v[48:49], v[52:53], v[12:13], v[48:49] op_sel:[0,0,0] op_sel_hi:[1,0,1]
    v_pk_fma_f32 v[50:51], v[54:55], v[12:13], v[50:51] op_sel:[0,0,0] op_sel_hi:[1,0,1]
    v_lshlrev_b32 v60, 16, v20
    v_lshlrev_b32 v216, 16, v21
    v_and_b32 v61, s5, v20
    v_and_b32 v217, s5, v21
    v_add_f32 v48, v96, v48
    v_add_f32 v50, v104, v50
    v_add_f32 v49, v100, v49
    v_add_f32 v51, v108, v51
    v_pk_fma_f32 v[48:49], v[32:33], v[48:49], v[60:61]
    v_pk_fma_f32 v[50:51], v[34:35], v[50:51], v[216:217]
    v_cvt_pk_bf16_f32 v20, v48, v49
    v_cvt_pk_bf16_f32 v21, v50, v51
    v_pk_mul_f32 v[48:49], v[48:49], v[208:209] op_sel:[0,0] op_sel_hi:[1,0]
    v_pk_mul_f32 v[50:51], v[50:51], v[208:209] op_sel:[0,0] op_sel_hi:[1,0]
    v_cvt_pk_bf16_f32 v28, v48, v49
    v_cvt_pk_bf16_f32 v29, v50, v51
    ds_read_u16_d16_hi v52, v10 offset:3072
    ds_read_u16_d16_hi v53, v10 offset:3328
    ds_read_u16_d16_hi v54, v10 offset:3584
    ds_read_u16_d16_hi v55, v10 offset:3840
    ds_read_b128 v[48:51], v9 offset:6528
    s_waitcnt lgkmcnt(0)
    v_pk_fma_f32 v[48:49], v[52:53], v[12:13], v[48:49] op_sel:[0,0,0] op_sel_hi:[1,0,1]
    v_pk_fma_f32 v[50:51], v[54:55], v[12:13], v[50:51] op_sel:[0,0,0] op_sel_hi:[1,0,1]
    v_lshlrev_b32 v60, 16, v22
    v_lshlrev_b32 v216, 16, v23
    v_and_b32 v61, s5, v22
    v_and_b32 v217, s5, v23
    v_add_f32 v48, v112, v48
    v_add_f32 v50, v120, v50
    v_add_f32 v49, v116, v49
    v_add_f32 v51, v124, v51
    v_pk_fma_f32 v[48:49], v[36:37], v[48:49], v[60:61]
    v_pk_fma_f32 v[50:51], v[38:39], v[50:51], v[216:217]
    v_cvt_pk_bf16_f32 v22, v48, v49
    v_cvt_pk_bf16_f32 v23, v50, v51
    v_pk_mul_f32 v[48:49], v[48:49], v[208:209] op_sel:[0,0] op_sel_hi:[1,0]
    v_pk_mul_f32 v[50:51], v[50:51], v[208:209] op_sel:[0,0] op_sel_hi:[1,0]
    v_cvt_pk_bf16_f32 v30, v48, v49
    v_cvt_pk_bf16_f32 v31, v50, v51
    v_permlane32_swap_b32 v24, v28
    v_permlane32_swap_b32 v25, v29
    v_permlane32_swap_b32 v26, v30
    v_permlane32_swap_b32 v27, v31
    buffer_store_dwordx4 v[24:27], v209, s[40:43], s30 offen sc1
    buffer_store_dwordx4 v[28:31], v209, s[40:43], s30 offen offset:256 sc1
    v_permlane32_swap_b32 v16, v20
    v_permlane32_swap_b32 v17, v21
    v_permlane32_swap_b32 v18, v22
    v_permlane32_swap_b32 v19, v23
    buffer_store_dwordx4 v[16:19], v209, s[40:43], s26 offen sc1
    buffer_store_dwordx4 v[20:23], v209, s[40:43], s26 offen offset:256 sc1
    v_lshlrev_b32 v1, 3, v0
    s_mov_b32 s16, 20977664
    buffer_load_dwordx2 v[64:65], v1, s[40:43], s16 offen
    buffer_load_dwordx2 v[66:67], v1, s[40:43], s16 offen offset:2048
    s_add_u32 s16, s16, 12288
    buffer_load_dwordx2 v[68:69], v1, s[40:43], s16 offen
    buffer_load_dwordx2 v[70:71], v1, s[40:43], s16 offen offset:2048
    s_add_u32 s16, s16, 12288
    buffer_load_dwordx2 v[72:73], v1, s[40:43], s16 offen
    buffer_load_dwordx2 v[74:75], v1, s[40:43], s16 offen offset:2048
    s_add_u32 s16, s16, 12288
    buffer_load_dwordx2 v[76:77], v1, s[40:43], s16 offen
    buffer_load_dwordx2 v[78:79], v1, s[40:43], s16 offen offset:2048
    s_mov_b32 s44, s24
    s_mov_b32 s45, s25
    s_mov_b32 s46, 2752
    s_mov_b32 s47, 0x20000
    v_lshlrev_b32 v7, 3, v3
    s_lshl_b32 s18, s13, 6
    s_lshl_b32 s19, s15, 5
    buffer_load_dwordx2 v[112:113], v7, s[44:47], s18 offen
    buffer_load_dwordx2 v[114:115], v7, s[44:47], s18 offen offset:32
    buffer_load_dwordx2 v[116:117], v7, s[44:47], s19 offen
    s_mov_b32 s7, 0
    s_nop 0
PL5:
    s_waitcnt vmcnt(15)
    v_cmp_ne_u64 vcc, s[60:61], v[252:253]
    s_add_u32 s7, s7, 1
    s_cmp_gt_u32 s7, 20000
    s_cselect_b64 vcc, 0, vcc
    s_cmp_eq_u64 vcc, 0
    s_nop 0
    s_cbranch_scc1 PL5D
    s_mov_b32 s6, 22052864
    buffer_load_dwordx2 v[252:253], v243, s[40:43], s6 offen offset:0 sc1
    s_waitcnt vmcnt(0)
    s_nop 0
    s_branch PL5
    s_nop 0
PL5D:
    s_waitcnt vmcnt(11)
    s_waitcnt lgkmcnt(0)
    s_barrier
    s_cmp_lg_u32 s4, 0
    s_nop 0
    s_cbranch_scc1 SF6
    s_lshl_b32 s3, s2, 6
    s_add_u32 s3, s3, 22069248
    v_mov_b32 v120, s60
    v_mov_b32 v121, s61
    v_mov_b32 v122, 0
    s_mov_b64 exec, 1
    buffer_store_dwordx2 v[120:121], v122, s[40:43], s3 offen sc1
    s_mov_b64 exec, -1
    s_nop 1
SF6:
    v_lshlrev_b32 v1, 2, v2
    s_lshr_b32 s3, s2, 5
    s_lshl_b32 s16, s3, 8
    s_add_u32 s16, s16, 20981760
    buffer_load_dword v120, v1, s[40:43], s16 offen
    s_add_u32 s16, s16, 12288
    buffer_load_dword v121, v1, s[40:43], s16 offen
    s_add_u32 s16, s16, 12288
    buffer_load_dword v122, v1, s[40:43], s16 offen
    s_add_u32 s16, s16, 12288
    buffer_load_dword v123, v1, s[40:43], s16 offen
    s_mov_b32 s44, s28
    s_mov_b32 s45, s29
    s_mov_b32 s46, 1024
    s_mov_b32 s47, 0x20000
    v_lshlrev_b32 v7, 1, v2
    s_lshl_b32 s16, s3, 7
    buffer_load_ushort v124, v7, s[44:47], s16 offen
    buffer_load_dwordx4 a[128:131], v6, s[40:43], s10 offen offset:0
    buffer_load_dwordx4 a[192:195], v6, s[40:43], s10 offen offset:1024
    buffer_load_dwordx4 v[128:131], v6, s[40:43], s12 offen offset:2048
    s_add_u32 s10, s10, 3072
    s_add_u32 s12, s12, 3072
    buffer_load_dwordx4 a[132:135], v6, s[40:43], s10 offen offset:0
    buffer_load_dwordx4 a[196:199], v6, s[40:43], s10 offen offset:1024
    buffer_load_dwordx4 v[132:135], v6, s[40:43], s12 offen offset:2048
    s_add_u32 s10, s10, 3072
    s_add_u32 s12, s12, 3072
    buffer_load_dwordx4 a[136:139], v6, s[40:43], s10 offen offset:0
    buffer_load_dwordx4 a[200:203], v6, s[40:43], s10 offen offset:1024
    buffer_load_dwordx4 v[136:139], v6, s[40:43], s12 offen offset:2048
    s_add_u32 s10, s10, 3072
    s_add_u32 s12, s12, 3072
    buffer_load_dwordx4 a[140:143], v6, s[40:43], s10 offen offset:0
    buffer_load_dwordx4 a[204:207], v6, s[40:43], s10 offen offset:1024
    buffer_load_dwordx4 v[140:143], v6, s[40:43], s12 offen offset:2048
    s_add_u32 s10, s10, 3072
    s_add_u32 s12, s12, 3072
    buffer_load_dwordx4 a[144:147], v6, s[40:43], s10 offen offset:0
    buffer_load_dwordx4 a[208:211], v6, s[40:43], s10 offen offset:1024
    buffer_load_dwordx4 v[144:147], v6, s[40:43], s12 offen offset:2048
    s_add_u32 s10, s10, 3072
    s_add_u32 s12, s12, 3072
    s_waitcnt vmcnt(28)
    v_pk_add_f32 v[64:65], v[64:65], v[68:69]
    s_waitcnt vmcnt(24)
    v_pk_add_f32 v[72:73], v[72:73], v[76:77]
    v_pk_add_f32 v[66:67], v[66:67], v[70:71]
    s_waitcnt vmcnt(23)
    v_pk_add_f32 v[74:75], v[74:75], v[78:79]
    v_pk_add_f32 v[64:65], v[64:65], v[72:73]
    v_pk_add_f32 v[66:67], v[66:67], v[74:75]
    v_cvt_pk_bf16_f32 v64, v64, v65
    v_cvt_pk_bf16_f32 v66, 0, v66
    v_cvt_pk_bf16_f32 v67, 0, v67
    v_add_f32 v66, 1.0, v66
    v_add_f32 v67, 1.0, v67
    v_cvt_pk_bf16_f32 v66, v66, v67
    v_lshlrev_b32 v1, 2, v0
    v_add_u32 v1, 131584, v1
    ds_write_b32 v1, v66
    ds_write_b32 v1, v64 offset:1024
    s_waitcnt vmcnt(22)
    v_lshlrev_b32 v20, 16, v112
    v_and_b32 v21, s5, v112
    v_lshlrev_b32 v22, 16, v113
    v_and_b32 v23, s5, v113
    s_waitcnt vmcnt(21)
    v_lshlrev_b32 v24, 16, v114
    v_and_b32 v25, s5, v114
    v_lshlrev_b32 v26, 16, v115
    v_and_b32 v27, s5, v115
    s_waitcnt vmcnt(20)
    v_lshlrev_b32 v28, 16, v116
    v_and_b32 v29, s5, v116
    v_lshlrev_b32 v30, 16, v117
    v_and_b32 v31, s5, v117
    s_waitcnt vmcnt(18)
    v_add_f32 v120, v120, v121
    s_waitcnt vmcnt(16)
    v_add_f32 v122, v122, v123
    v_add_f32 v120, v120, v122
    v_cvt_pk_bf16_f32 v120, 0, v120
    s_waitcnt vmcnt(15)
    v_lshlrev_b32 v124, 16, v124
    s_lshl_b32 s3, s4, 9
    s_add_u32 s3, s3, 141824
    v_lshl_add_u32 v1, v2, 2, s3
    ds_write_b32 v1, v120
    ds_write_b32 v1, v124 offset:256
    s_waitcnt lgkmcnt(0)
    s_barrier
    v_and_b32 v1, 1, v0
    v_lshlrev_b32 v1, 10, v1
    v_lshl_add_u32 v1, v3, 4, v1
    v_add_u32 v1, 131584, v1
    ds_read_b128 v[32:35], v1 offset:0
    ds_read_b128 v[36:39], v1 offset:64
    ds_read_b128 v[40:43], v1 offset:128
    ds_read_b128 v[44:47], v1 offset:192
    ds_read_b128 v[48:51], v1 offset:256
    ds_read_b128 v[52:55], v1 offset:320
    ds_read_b128 v[56:59], v1 offset:384
    ds_read_b128 v[60:63], v1 offset:448
    ds_read_b128 v[64:67], v1 offset:512
    ds_read_b128 v[68:71], v1 offset:576
    ds_read_b128 v[72:75], v1 offset:640
    ds_read_b128 v[76:79], v1 offset:704
    ds_read_b128 v[80:83], v1 offset:768
    ds_read_b128 v[84:87], v1 offset:832
    ds_read_b128 v[88:91], v1 offset:896
    ds_read_b128 v[92:95], v1 offset:960
    buffer_load_dwordx4 a[148:151], v6, s[40:43], s10 offen offset:0
    buffer_load_dwordx4 a[212:215], v6, s[40:43], s10 offen offset:1024
    buffer_load_dwordx4 v[148:151], v6, s[40:43], s12 offen offset:2048
    s_add_u32 s10, s10, 3072
    s_add_u32 s12, s12, 3072
    s_lshr_b32 s27, s2, 5
    s_lshl_b32 s27, s27, 2
    s_add_u32 s27, s27, s4
    s_mul_i32 s27, s27, 45056
    s_add_u32 s27, s27, 18874368
    v_mov_b32 v248, 0x3f803f80
    v_mov_b32 v249, 0x3f803f80
    v_mov_b32 v250, 0x3f803f80
    v_mov_b32 v251, 0x3f803f80
    v_lshrrev_b32 v1, 3, v2
    v_and_b32 v7, 7, v0
    v_and_b32 v112, 2, v1
    v_xor_b32 v7, v7, v112
    s_and_b32 s3, s4, 1
    s_lshl_b32 s3, s3, 2
    v_xor_b32 v7, s3, v7
    v_mul_u32_u24 v1, 4352, v1
    v_lshl_add_u32 v1, v7, 4, v1
    s_mul_i32 s16, s4, 34816
    s_lshl_b32 s17, s8, 7
    s_add_u32 s16, s16, s17
    s_add_u32 s18, s16, 5242880
    s_add_u32 s16, s16, 7864320
    s_lshl_b32 s17, s4, 10
    v_lshl_add_u32 v7, v3, 3, v4
    v_lshlrev_b32 v7, 7, v7
    v_lshl_add_u32 v7, v5, 3, v7
    v_lshrrev_b32 v112, 1, v4
    v_and_b32 v113, 1, v3
    v_lshl_add_u32 v112, v113, 1, v112
    s_add_u32 s3, s4, 0
    s_and_b32 s3, s3, 3
    v_xor_b32 v113, s3, v112
    v_lshl_add_u32 v244, v113, 5, v7
    s_add_u32 s3, s4, 1
    s_and_b32 s3, s3, 3
    v_xor_b32 v113, s3, v112
    v_lshl_add_u32 v245, v113, 5, v7
    s_add_u32 s3, s4, 2
    s_and_b32 s3, s3, 3
    v_xor_b32 v113, s3, v112
    v_lshl_add_u32 v246, v113, 5, v7
    s_add_u32 s3, s4, 3
    s_and_b32 s3, s3, 3
    v_xor_b32 v113, s3, v112
    v_lshl_add_u32 v247, v113, 5, v7
    v_add_u32 v255, 65536, v244
    buffer_load_dwordx4 a[152:155], v6, s[40:43], s10 offen offset:0
    buffer_load_dwordx4 a[216:219], v6, s[40:43], s10 offen offset:1024
    buffer_load_dwordx4 v[152:155], v6, s[40:43], s12 offen offset:2048
    s_add_u32 s10, s10, 3072
    s_add_u32 s12, s12, 3072
    s_waitcnt vmcnt(20) lgkmcnt(15)
    v_mfma_f32_16x16x32_bf16 v[96:99], a[128:131], v[32:35], 0
    s_waitcnt vmcnt(19)
    v_mfma_f32_16x16x32_bf16 v[100:103], a[192:195], v[32:35], 0
    s_waitcnt vmcnt(18)
    v_mfma_f32_16x16x32_bf16 v[104:107], v[128:131], v[32:35], 0
    buffer_load_dwordx4 a[156:159], v6, s[40:43], s10 offen offset:0
    buffer_load_dwordx4 a[220:223], v6, s[40:43], s10 offen offset:1024
    buffer_load_dwordx4 v[156:159], v6, s[40:43], s12 offen offset:2048
    s_add_u32 s10, s10, 3072
    s_add_u32 s12, s12, 3072
    s_waitcnt vmcnt(20) lgkmcnt(14)
    v_mfma_f32_16x16x32_bf16 v[96:99], a[132:135], v[36:39], v[96:99]
    s_waitcnt vmcnt(19)
    v_mfma_f32_16x16x32_bf16 v[100:103], a[196:199], v[36:39], v[100:103]
    s_waitcnt vmcnt(18)
    v_mfma_f32_16x16x32_bf16 v[104:107], v[132:135], v[36:39], v[104:107]
    buffer_load_dwordx4 a[160:163], v6, s[40:43], s10 offen offset:0
    buffer_load_dwordx4 a[224:227], v6, s[40:43], s10 offen offset:1024
    buffer_load_dwordx4 v[160:163], v6, s[40:43], s12 offen offset:2048
    s_add_u32 s10, s10, 3072
    s_add_u32 s12, s12, 3072
    s_waitcnt vmcnt(20) lgkmcnt(13)
    v_mfma_f32_16x16x32_bf16 v[96:99], a[136:139], v[40:43], v[96:99]
    s_waitcnt vmcnt(19)
    v_mfma_f32_16x16x32_bf16 v[100:103], a[200:203], v[40:43], v[100:103]
    s_waitcnt vmcnt(18)
    v_mfma_f32_16x16x32_bf16 v[104:107], v[136:139], v[40:43], v[104:107]
    buffer_load_dwordx4 a[164:167], v6, s[40:43], s10 offen offset:0
    buffer_load_dwordx4 a[228:231], v6, s[40:43], s10 offen offset:1024
    buffer_load_dwordx4 v[164:167], v6, s[40:43], s12 offen offset:2048
    s_add_u32 s10, s10, 3072
    s_add_u32 s12, s12, 3072
    s_waitcnt vmcnt(20) lgkmcnt(12)
    v_mfma_f32_16x16x32_bf16 v[96:99], a[140:143], v[44:47], v[96:99]
    s_waitcnt vmcnt(19)
    v_mfma_f32_16x16x32_bf16 v[100:103], a[204:207], v[44:47], v[100:103]
    s_waitcnt vmcnt(18)
    v_mfma_f32_16x16x32_bf16 v[104:107], v[140:143], v[44:47], v[104:107]
    buffer_load_dwordx4 a[168:171], v6, s[40:43], s10 offen offset:0
    buffer_load_dwordx4 a[232:235], v6, s[40:43], s10 offen offset:1024
    buffer_load_dwordx4 v[168:171], v6, s[40:43], s12 offen offset:2048
    s_add_u32 s10, s10, 3072
    s_add_u32 s12, s12, 3072
    s_waitcnt vmcnt(20) lgkmcnt(11)
    v_mfma_f32_16x16x32_bf16 v[96:99], a[144:147], v[48:51], v[96:99]
    s_waitcnt vmcnt(19)
    v_mfma_f32_16x16x32_bf16 v[100:103], a[208:211], v[48:51], v[100:103]
    s_waitcnt vmcnt(18)
    v_mfma_f32_16x16x32_bf16 v[104:107], v[144:147], v[48:51], v[104:107]
    buffer_load_dwordx4 a[172:175], v6, s[40:43], s10 offen offset:0
    buffer_load_dwordx4 a[236:239], v6, s[40:43], s10 offen offset:1024
    buffer_load_dwordx4 v[172:175], v6, s[40:43], s12 offen offset:2048
    s_add_u32 s10, s10, 3072
    s_add_u32 s12, s12, 3072
    s_waitcnt vmcnt(20) lgkmcnt(10)
    v_mfma_f32_16x16x32_bf16 v[96:99], a[148:151], v[52:55], v[96:99]
    s_waitcnt vmcnt(19)
    v_mfma_f32_16x16x32_bf16 v[100:103], a[212:215], v[52:55], v[100:103]
    s_waitcnt vmcnt(18)
    v_mfma_f32_16x16x32_bf16 v[104:107], v[148:151], v[52:55], v[104:107]
    s_mov_b32 s6, 22069248
    buffer_load_dwordx2 v[252:253], v243, s[40:43], s6 offen offset:0 sc1
    buffer_load_dwordx4 a[176:179], v6, s[40:43], s10 offen offset:0
    buffer_load_dwordx4 a[240:243], v6, s[40:43], s10 offen offset:1024
    buffer_load_dwordx4 v[176:179], v6, s[40:43], s12 offen offset:2048
    s_add_u32 s10, s10, 3072
    s_add_u32 s12, s12, 3072
    s_waitcnt vmcnt(21) lgkmcnt(9)
    v_mfma_f32_16x16x32_bf16 v[96:99], a[152:155], v[56:59], v[96:99]
    s_waitcnt vmcnt(20)
    v_mfma_f32_16x16x32_bf16 v[100:103], a[216:219], v[56:59], v[100:103]
    s_waitcnt vmcnt(19)
    v_mfma_f32_16x16x32_bf16 v[104:107], v[152:155], v[56:59], v[104:107]
    buffer_load_dwordx4 a[180:183], v6, s[40:43], s10 offen offset:0
    buffer_load_dwordx4 a[244:247], v6, s[40:43], s10 offen offset:1024
    buffer_load_dwordx4 v[180:183], v6, s[40:43], s12 offen offset:2048
    s_add_u32 s10, s10, 3072
    s_add_u32 s12, s12, 3072
    s_waitcnt vmcnt(21) lgkmcnt(8)
    v_mfma_f32_16x16x32_bf16 v[96:99], a[156:159], v[60:63], v[96:99]
    s_waitcnt vmcnt(20)
    v_mfma_f32_16x16x32_bf16 v[100:103], a[220:223], v[60:63], v[100:103]
    s_waitcnt vmcnt(19)
    v_mfma_f32_16x16x32_bf16 v[104:107], v[156:159], v[60:63], v[104:107]
    buffer_load_dwordx4 a[184:187], v6, s[40:43], s10 offen offset:0
    buffer_load_dwordx4 a[248:251], v6, s[40:43], s10 offen offset:1024
    buffer_load_dwordx4 v[184:187], v6, s[40:43], s12 offen offset:2048
    s_add_u32 s10, s10, 3072
    s_add_u32 s12, s12, 3072
    s_waitcnt vmcnt(21) lgkmcnt(7)
    v_mfma_f32_16x16x32_bf16 v[96:99], a[160:163], v[64:67], v[96:99]
    s_waitcnt vmcnt(20)
    v_mfma_f32_16x16x32_bf16 v[100:103], a[224:227], v[64:67], v[100:103]
    s_waitcnt vmcnt(19)
    v_mfma_f32_16x16x32_bf16 v[104:107], v[160:163], v[64:67], v[104:107]
    buffer_load_dwordx4 a[188:191], v6, s[40:43], s10 offen offset:0
    buffer_load_dwordx4 a[252:255], v6, s[40:43], s10 offen offset:1024
    buffer_load_dwordx4 v[188:191], v6, s[40:43], s12 offen offset:2048
    s_waitcnt vmcnt(21) lgkmcnt(6)
    v_mfma_f32_16x16x32_bf16 v[96:99], a[164:167], v[68:71], v[96:99]
    s_waitcnt vmcnt(20)
    v_mfma_f32_16x16x32_bf16 v[100:103], a[228:231], v[68:71], v[100:103]
    s_waitcnt vmcnt(19)
    v_mfma_f32_16x16x32_bf16 v[104:107], v[164:167], v[68:71], v[104:107]
    s_mov_b32 s7, 0
    s_nop 6
PL7:
    s_waitcnt vmcnt(12)
    v_cmp_ne_u64 vcc, s[60:61], v[252:253]
    s_add_u32 s7, s7, 1
    s_cmp_gt_u32 s7, 20000
    s_cselect_b64 vcc, 0, vcc
    s_cmp_eq_u64 vcc, 0
    s_nop 0
    s_cbranch_scc1 PL7D
    s_mov_b32 s6, 22069248
    buffer_load_dwordx2 v[252:253], v243, s[40:43], s6 offen offset:0 sc1
    s_waitcnt vmcnt(0)
    s_nop 0
    s_branch PL7
    s_nop 0
PL7D:
    s_barrier
    s_mul_i32 s3, s9, 278528
    s_add_u32 s18, s18, s3
    s_add_u32 s3, s17, 65536
    s_mov_b32 m0, s3
    s_nop 0
    buffer_load_dwordx4 v1, s[40:43], s18 offen  lds
    s_add_u32 s18, s18, 139264
    s_add_u32 s3, s3, 4096
    s_mov_b32 m0, s3
    s_nop 0
    buffer_load_dwordx4 v1, s[40:43], s18 offen  lds
    s_add_u32 s18, s18, 139264
    s_add_u32 s3, s3, 4096
    s_mov_b32 m0, s17
    s_nop 0
    buffer_load_dwordx4 v1, s[40:43], s16 offen  lds
    s_add_u32 s16, s16, 139264
    s_add_u32 s17, s17, 4096
    s_mov_b32 m0, s17
    s_nop 0
    buffer_load_dwordx4 v1, s[40:43], s16 offen  lds
    s_add_u32 s16, s16, 139264
    s_add_u32 s17, s17, 4096
    s_mov_b32 m0, s17
    s_nop 0
    buffer_load_dwordx4 v1, s[40:43], s16 offen  lds
    s_add_u32 s16, s16, 139264
    s_add_u32 s17, s17, 4096
    s_mov_b32 m0, s17
    s_nop 0
    buffer_load_dwordx4 v1, s[40:43], s16 offen  lds
    s_add_u32 s16, s16, 139264
    s_add_u32 s17, s17, 4096
    s_mov_b32 m0, s17
    s_nop 0
    buffer_load_dwordx4 v1, s[40:43], s16 offen  lds
    s_add_u32 s16, s16, 139264
    s_add_u32 s17, s17, 4096
    s_mov_b32 m0, s17
    s_nop 0
    buffer_load_dwordx4 v1, s[40:43], s16 offen  lds
    s_add_u32 s16, s16, 139264
    s_add_u32 s17, s17, 4096
    s_mov_b32 m0, s17
    s_nop 0
    buffer_load_dwordx4 v1, s[40:43], s16 offen  lds
    s_add_u32 s16, s16, 139264
    s_add_u32 s17, s17, 4096
    s_mov_b32 m0, s17
    s_nop 0
    buffer_load_dwordx4 v1, s[40:43], s16 offen  lds
    s_add_u32 s16, s16, 139264
    s_add_u32 s17, s17, 4096
    s_mov_b32 m0, s17
    s_nop 0
    buffer_load_dwordx4 v1, s[40:43], s16 offen  lds
    s_add_u32 s16, s16, 139264
    s_add_u32 s17, s17, 4096
    s_mov_b32 m0, s17
    s_nop 0
    buffer_load_dwordx4 v1, s[40:43], s16 offen  lds
    s_add_u32 s16, s16, 139264
    s_add_u32 s17, s17, 4096
    s_mov_b32 m0, s17
    s_nop 0
    buffer_load_dwordx4 v1, s[40:43], s16 offen  lds
    s_add_u32 s16, s16, 139264
    s_add_u32 s17, s17, 4096
    s_mov_b32 m0, s17
    s_nop 0
    buffer_load_dwordx4 v1, s[40:43], s16 offen  lds
    s_add_u32 s16, s16, 139264
    s_add_u32 s17, s17, 4096
    s_mov_b32 m0, s17
    s_nop 0
    buffer_load_dwordx4 v1, s[40:43], s16 offen  lds
    s_add_u32 s16, s16, 139264
    s_add_u32 s17, s17, 4096
    s_mov_b32 m0, s17
    s_nop 0
    buffer_load_dwordx4 v1, s[40:43], s16 offen  lds
    s_add_u32 s16, s16, 139264
    s_add_u32 s17, s17, 4096
    s_mov_b32 m0, s17
    s_nop 0
    buffer_load_dwordx4 v1, s[40:43], s16 offen  lds
    s_add_u32 s16, s16, 139264
    s_add_u32 s17, s17, 4096
    s_mov_b32 m0, s17
    s_nop 0
    buffer_load_dwordx4 v1, s[40:43], s16 offen  lds
    s_add_u32 s16, s16, 139264
    s_add_u32 s17, s17, 4096
    s_waitcnt lgkmcnt(5)
    v_mfma_f32_16x16x32_bf16 v[96:99], a[168:171], v[72:75], v[96:99]
    v_mfma_f32_16x16x32_bf16 v[100:103], a[232:235], v[72:75], v[100:103]
    v_mfma_f32_16x16x32_bf16 v[104:107], v[168:171], v[72:75], v[104:107]
    s_waitcnt lgkmcnt(4)
    v_mfma_f32_16x16x32_bf16 v[96:99], a[172:175], v[76:79], v[96:99]
    v_mfma_f32_16x16x32_bf16 v[100:103], a[236:239], v[76:79], v[100:103]
    v_mfma_f32_16x16x32_bf16 v[104:107], v[172:175], v[76:79], v[104:107]
    s_waitcnt vmcnt(29) lgkmcnt(3)
    v_mfma_f32_16x16x32_bf16 v[96:99], a[176:179], v[80:83], v[96:99]
    s_waitcnt vmcnt(28)
    v_mfma_f32_16x16x32_bf16 v[100:103], a[240:243], v[80:83], v[100:103]
    s_waitcnt vmcnt(27)
    v_mfma_f32_16x16x32_bf16 v[104:107], v[176:179], v[80:83], v[104:107]
    s_waitcnt vmcnt(26) lgkmcnt(2)
    v_mfma_f32_16x16x32_bf16 v[96:99], a[180:183], v[84:87], v[96:99]
    s_waitcnt vmcnt(25)
    v_mfma_f32_16x16x32_bf16 v[100:103], a[244:247], v[84:87], v[100:103]
    s_waitcnt vmcnt(24)
    v_mfma_f32_16x16x32_bf16 v[104:107], v[180:183], v[84:87], v[104:107]
    s_waitcnt vmcnt(23) lgkmcnt(1)
    v_mfma_f32_16x16x32_bf16 v[96:99], a[184:187], v[88:91], v[96:99]
    s_waitcnt vmcnt(22)
    v_mfma_f32_16x16x32_bf16 v[100:103], a[248:251], v[88:91], v[100:103]
    s_waitcnt vmcnt(21)
    v_mfma_f32_16x16x32_bf16 v[104:107], v[184:187], v[88:91], v[104:107]
    s_waitcnt vmcnt(20) lgkmcnt(0)
    v_mfma_f32_16x16x32_bf16 v[96:99], a[188:191], v[92:95], v[96:99]
    s_waitcnt vmcnt(19)
    v_mfma_f32_16x16x32_bf16 v[100:103], a[252:255], v[92:95], v[100:103]
    s_waitcnt vmcnt(18)
    v_mfma_f32_16x16x32_bf16 v[104:107], v[188:191], v[92:95], v[104:107]
    s_nop 3
    v_add_f32_dpp v20, v96, v20 quad_perm:[1,1,3,3] row_mask:0xf bank_mask:0xf
    v_add_f32_dpp v21, v97, v21 quad_perm:[1,1,3,3] row_mask:0xf bank_mask:0xf
    v_add_f32_dpp v22, v98, v22 quad_perm:[1,1,3,3] row_mask:0xf bank_mask:0xf
    v_add_f32_dpp v23, v99, v23 quad_perm:[1,1,3,3] row_mask:0xf bank_mask:0xf
    v_add_f32_dpp v24, v100, v24 quad_perm:[1,1,3,3] row_mask:0xf bank_mask:0xf
    v_add_f32_dpp v25, v101, v25 quad_perm:[1,1,3,3] row_mask:0xf bank_mask:0xf
    v_add_f32_dpp v26, v102, v26 quad_perm:[1,1,3,3] row_mask:0xf bank_mask:0xf
    v_add_f32_dpp v27, v103, v27 quad_perm:[1,1,3,3] row_mask:0xf bank_mask:0xf
    v_add_f32_dpp v28, v104, v28 quad_perm:[1,1,3,3] row_mask:0xf bank_mask:0xf
    v_add_f32_dpp v29, v105, v29 quad_perm:[1,1,3,3] row_mask:0xf bank_mask:0xf
    v_add_f32_dpp v30, v106, v30 quad_perm:[1,1,3,3] row_mask:0xf bank_mask:0xf
    v_add_f32_dpp v31, v107, v31 quad_perm:[1,1,3,3] row_mask:0xf bank_mask:0xf
    v_mov_b32_dpp v8, v96 quad_perm:[0,0,2,2] row_mask:0xf bank_mask:0xf
    v_mov_b32_dpp v9, v97 quad_perm:[0,0,2,2] row_mask:0xf bank_mask:0xf
    v_mov_b32_dpp v10, v98 quad_perm:[0,0,2,2] row_mask:0xf bank_mask:0xf
    v_mov_b32_dpp v11, v99 quad_perm:[0,0,2,2] row_mask:0xf bank_mask:0xf
    v_mov_b32_dpp v12, v100 quad_perm:[0,0,2,2] row_mask:0xf bank_mask:0xf
    v_mov_b32_dpp v13, v101 quad_perm:[0,0,2,2] row_mask:0xf bank_mask:0xf
    v_mov_b32_dpp v14, v102 quad_perm:[0,0,2,2] row_mask:0xf bank_mask:0xf
    v_mov_b32_dpp v15, v103 quad_perm:[0,0,2,2] row_mask:0xf bank_mask:0xf
    v_mov_b32_dpp v16, v104 quad_perm:[0,0,2,2] row_mask:0xf bank_mask:0xf
    v_mov_b32_dpp v17, v105 quad_perm:[0,0,2,2] row_mask:0xf bank_mask:0xf
    v_mov_b32_dpp v18, v106 quad_perm:[0,0,2,2] row_mask:0xf bank_mask:0xf
    v_mov_b32_dpp v19, v107 quad_perm:[0,0,2,2] row_mask:0xf bank_mask:0xf
    s_lshr_b32 s31, s2, 5
    s_mul_i32 s31, s31, 278528
    s_mul_i32 s3, s4, 34816
    s_add_u32 s31, s31, s3
    s_and_b32 s3, s2, 31
    s_lshl_b32 s3, s3, 7
    s_add_u32 s31, s31, s3
    s_add_u32 s31, s31, 5242880
    s_lshl_b32 s30, s4, 10
    s_add_u32 s30, s30, 133632
    s_waitcnt vmcnt(12)
    s_barrier
    ds_read_b64_tr_b16 v[32:33], v244 offset:0
    ds_read_b64_tr_b16 v[34:35], v244 offset:512
    ds_read_b64_tr_b16 v[36:37], v245 offset:0
    ds_read_b64_tr_b16 v[38:39], v245 offset:512
    ds_read_b64_tr_b16 v[40:41], v246 offset:0
    ds_read_b64_tr_b16 v[42:43], v246 offset:512
    ds_read_b64_tr_b16 v[44:45], v247 offset:0
    ds_read_b64_tr_b16 v[46:47], v247 offset:512
    s_waitcnt lgkmcnt(6)
    v_mfma_f32_16x16x32_bf16 v[64:67], a[128:131], v[32:35], 0
    ds_read_b64_tr_b16 v[112:113], v255 offset:0
    ds_read_b64_tr_b16 v[114:115], v255 offset:512
    s_waitcnt lgkmcnt(6)
    v_mfma_f32_16x16x32_bf16 v[68:71], a[128:131], v[36:39], 0
    ds_read_b64_tr_b16 v[116:117], v255 offset:4096
    ds_read_b64_tr_b16 v[118:119], v255 offset:4608
    s_waitcnt lgkmcnt(6)
    v_mfma_f32_16x16x32_bf16 v[72:75], a[128:131], v[40:43], 0
    ds_read_b64_tr_b16 v[48:49], v244 offset:4096
    ds_read_b64_tr_b16 v[50:51], v244 offset:4608
    s_waitcnt lgkmcnt(6)
    v_mfma_f32_16x16x32_bf16 v[76:79], a[128:131], v[44:47], 0
    ds_read_b64_tr_b16 v[52:53], v245 offset:4096
    ds_read_b64_tr_b16 v[54:55], v245 offset:4608
    v_mfma_f32_16x16x32_bf16 v[80:83], a[192:195], v[32:35], 0
    ds_read_b64_tr_b16 v[56:57], v246 offset:4096
    ds_read_b64_tr_b16 v[58:59], v246 offset:4608
    v_mfma_f32_16x16x32_bf16 v[84:87], a[192:195], v[36:39], 0
    ds_read_b64_tr_b16 v[60:61], v247 offset:4096
    ds_read_b64_tr_b16 v[62:63], v247 offset:4608
    v_mfma_f32_16x16x32_bf16 v[88:91], a[192:195], v[40:43], 0
    s_mov_b32 m0, s30
    s_nop 0
    buffer_load_dwordx4 v1, s[40:43], s31 offen  lds
    s_add_u32 s31, s31, 139264
    s_add_u32 s30, s30, 4096
    s_mov_b32 m0, s30
    s_nop 0
    buffer_load_dwordx4 v1, s[40:43], s31 offen  lds
    v_mfma_f32_16x16x32_bf16 v[92:95], a[192:195], v[44:47], 0
    v_mfma_f32_16x16x32_bf16 v[96:99], v[128:131], v[32:35], 0
    v_mfma_f32_16x16x32_bf16 v[100:103], v[128:131], v[36:39], 0
    v_mfma_f32_16x16x32_bf16 v[104:107], v[128:131], v[40:43], 0
    v_mfma_f32_16x16x32_bf16 v[108:111], v[128:131], v[44:47], 0
    s_waitcnt lgkmcnt(6)
    v_mfma_f32_16x16x32_bf16 v[64:67], a[132:135], v[48:51], v[64:67]
    v_mfma_f32_16x16x32_bf16 v[120:123], v[112:115], v[112:115], 0
    v_mfma_f32_16x16x32_bf16 v[124:127], v[248:251], v[112:115], 0
    s_waitcnt lgkmcnt(4)
    v_mfma_f32_16x16x32_bf16 v[68:71], a[132:135], v[52:55], v[68:71]
    v_mfma_f32_16x16x32_bf16 v[120:123], v[116:119], v[116:119], v[120:123]
    v_mfma_f32_16x16x32_bf16 v[124:127], v[248:251], v[116:119], v[124:127]
    s_waitcnt lgkmcnt(2)
    v_mfma_f32_16x16x32_bf16 v[72:75], a[132:135], v[56:59], v[72:75]
    ds_read_b64_tr_b16 v[32:33], v244 offset:8192
    ds_read_b64_tr_b16 v[34:35], v244 offset:8704
    s_waitcnt lgkmcnt(2)
    v_mfma_f32_16x16x32_bf16 v[76:79], a[132:135], v[60:63], v[76:79]
    ds_read_b64_tr_b16 v[36:37], v245 offset:8192
    ds_read_b64_tr_b16 v[38:39], v245 offset:8704
    v_mfma_f32_16x16x32_bf16 v[80:83], a[196:199], v[48:51], v[80:83]
    ds_read_b64_tr_b16 v[40:41], v246 offset:8192
    ds_read_b64_tr_b16 v[42:43], v246 offset:8704
    v_mfma_f32_16x16x32_bf16 v[84:87], a[196:199], v[52:55], v[84:87]
    ds_read_b64_tr_b16 v[44:45], v247 offset:8192
    ds_read_b64_tr_b16 v[46:47], v247 offset:8704
    v_mfma_f32_16x16x32_bf16 v[88:91], a[196:199], v[56:59], v[88:91]
    v_mfma_f32_16x16x32_bf16 v[92:95], a[196:199], v[60:63], v[92:95]
    v_mfma_f32_16x16x32_bf16 v[96:99], v[132:135], v[48:51], v[96:99]
    v_mfma_f32_16x16x32_bf16 v[100:103], v[132:135], v[52:55], v[100:103]
    v_mfma_f32_16x16x32_bf16 v[104:107], v[132:135], v[56:59], v[104:107]
    v_mfma_f32_16x16x32_bf16 v[108:111], v[132:135], v[60:63], v[108:111]
    s_waitcnt lgkmcnt(6)
    v_mfma_f32_16x16x32_bf16 v[64:67], a[136:139], v[32:35], v[64:67]
    ds_read_b64_tr_b16 v[48:49], v244 offset:12288
    ds_read_b64_tr_b16 v[50:51], v244 offset:12800
    ds_read_b64_tr_b16 v[52:53], v245 offset:12288
    s_waitcnt lgkmcnt(7)
    v_mfma_f32_16x16x32_bf16 v[68:71], a[136:139], v[36:39], v[68:71]
    ds_read_b64_tr_b16 v[54:55], v245 offset:12800
    ds_read_b64_tr_b16 v[56:57], v246 offset:12288
    ds_read_b64_tr_b16 v[58:59], v246 offset:12800
    s_waitcnt lgkmcnt(8)
    v_mfma_f32_16x16x32_bf16 v[72:75], a[136:139], v[40:43], v[72:75]
    ds_read_b64_tr_b16 v[60:61], v247 offset:12288
    ds_read_b64_tr_b16 v[62:63], v247 offset:12800
    v_cmp_eq_u32 vcc, 1, v5
    s_waitcnt lgkmcnt(8)
    v_mfma_f32_16x16x32_bf16 v[76:79], a[136:139], v[44:47], v[76:79]
    v_cndmask_b32 v120, v120, v121, vcc
    v_cmp_eq_u32 vcc, 2, v5
    s_nop 1
    v_cndmask_b32 v120, v120, v122, vcc
    v_mfma_f32_16x16x32_bf16 v[80:83], a[200:203], v[32:35], v[80:83]
    v_cmp_eq_u32 vcc, 3, v5
    s_nop 1
    v_cndmask_b32 v120, v120, v123, vcc
    v_mov_b32 v122, v124
    v_mfma_f32_16x16x32_bf16 v[84:87], a[200:203], v[36:39], v[84:87]
    v_mov_b32 v121, s60
    v_mov_b32 v123, s60
    v_and_b32 v241, 15, v0
    v_mfma_f32_16x16x32_bf16 v[88:91], a[200:203], v[40:43], v[88:91]
    v_lshlrev_b32 v241, 4, v241
    s_lshl_b32 s20, s8, 13
    s_lshl_b32 s3, s4, 8
    v_mfma_f32_16x16x32_bf16 v[92:95], a[200:203], v[44:47], v[92:95]
    s_add_u32 s20, s20, s3
    s_add_u32 s20, s20, 21495808
    s_lshl_b32 s3, s9, 10
    v_mfma_f32_16x16x32_bf16 v[96:99], v[136:139], v[32:35], v[96:99]
    s_add_u32 s21, s20, s3
    s_mov_b32 s6, 0x00f0000f
    s_mov_b32 s7, 0xf0000f00
    v_mfma_f32_16x16x32_bf16 v[100:103], v[136:139], v[36:39], v[100:103]
    s_mov_b64 exec, s[6:7]
    buffer_store_dwordx4 v[120:123], v241, s[40:43], s21 offen sc1
    s_mov_b64 exec, -1
    s_add_u32 s21, s20, 4096
    v_mfma_f32_16x16x32_bf16 v[104:107], v[136:139], v[40:43], v[104:107]
    v_mfma_f32_16x16x32_bf16 v[108:111], v[136:139], v[44:47], v[108:111]
    s_waitcnt lgkmcnt(6)
    v_mfma_f32_16x16x32_bf16 v[64:67], a[140:143], v[48:51], v[64:67]
    s_waitcnt vmcnt(11)
    s_barrier
    s_waitcnt lgkmcnt(4)
    v_mfma_f32_16x16x32_bf16 v[68:71], a[140:143], v[52:55], v[68:71]
    ds_read_b64_tr_b16 v[32:33], v244 offset:16384
    ds_read_b64_tr_b16 v[34:35], v244 offset:16896
    s_waitcnt lgkmcnt(4)
    v_mfma_f32_16x16x32_bf16 v[72:75], a[140:143], v[56:59], v[72:75]
    ds_read_b64_tr_b16 v[36:37], v245 offset:16384
    ds_read_b64_tr_b16 v[38:39], v245 offset:16896
    s_waitcnt lgkmcnt(4)
    v_mfma_f32_16x16x32_bf16 v[76:79], a[140:143], v[60:63], v[76:79]
    ds_read_b64_tr_b16 v[40:41], v246 offset:16384
    ds_read_b64_tr_b16 v[42:43], v246 offset:16896
    v_mfma_f32_16x16x32_bf16 v[80:83], a[204:207], v[48:51], v[80:83]
    ds_read_b64_tr_b16 v[44:45], v247 offset:16384
    ds_read_b64_tr_b16 v[46:47], v247 offset:16896
    v_mfma_f32_16x16x32_bf16 v[84:87], a[204:207], v[52:55], v[84:87]
    v_mfma_f32_16x16x32_bf16 v[88:91], a[204:207], v[56:59], v[88:91]
    v_mfma_f32_16x16x32_bf16 v[92:95], a[204:207], v[60:63], v[92:95]
    v_mfma_f32_16x16x32_bf16 v[96:99], v[140:143], v[48:51], v[96:99]
    v_mfma_f32_16x16x32_bf16 v[100:103], v[140:143], v[52:55], v[100:103]
    v_mfma_f32_16x16x32_bf16 v[104:107], v[140:143], v[56:59], v[104:107]
    v_mfma_f32_16x16x32_bf16 v[108:111], v[140:143], v[60:63], v[108:111]
    buffer_load_dwordx4 a[0:3], v6, s[40:43], s27 offen offset:0
    s_waitcnt lgkmcnt(6)
    v_mfma_f32_16x16x32_bf16 v[64:67], a[144:147], v[32:35], v[64:67]
    ds_read_b64_tr_b16 v[48:49], v244 offset:20480
    ds_read_b64_tr_b16 v[50:51], v244 offset:20992
    s_waitcnt lgkmcnt(6)
    v_mfma_f32_16x16x32_bf16 v[68:71], a[144:147], v[36:39], v[68:71]
    ds_read_b64_tr_b16 v[52:53], v245 offset:20480
    ds_read_b64_tr_b16 v[54:55], v245 offset:20992
    s_waitcnt lgkmcnt(6)
    v_mfma_f32_16x16x32_bf16 v[72:75], a[144:147], v[40:43], v[72:75]
    ds_read_b64_tr_b16 v[56:57], v246 offset:20480
    ds_read_b64_tr_b16 v[58:59], v246 offset:20992
    s_waitcnt lgkmcnt(6)
    v_mfma_f32_16x16x32_bf16 v[76:79], a[144:147], v[44:47], v[76:79]
    ds_read_b64_tr_b16 v[60:61], v247 offset:20480
    ds_read_b64_tr_b16 v[62:63], v247 offset:20992
    buffer_load_dwordx4 a[4:7], v6, s[40:43], s27 offen offset:1024
    v_mfma_f32_16x16x32_bf16 v[80:83], a[208:211], v[32:35], v[80:83]
    v_mfma_f32_16x16x32_bf16 v[84:87], a[208:211], v[36:39], v[84:87]
    v_mfma_f32_16x16x32_bf16 v[88:91], a[208:211], v[40:43], v[88:91]
    v_mfma_f32_16x16x32_bf16 v[92:95], a[208:211], v[44:47], v[92:95]
    buffer_load_dwordx4 a[8:11], v6, s[40:43], s27 offen offset:2048
    v_mfma_f32_16x16x32_bf16 v[96:99], v[144:147], v[32:35], v[96:99]
    v_mfma_f32_16x16x32_bf16 v[100:103], v[144:147], v[36:39], v[100:103]
    v_mfma_f32_16x16x32_bf16 v[104:107], v[144:147], v[40:43], v[104:107]
    v_mfma_f32_16x16x32_bf16 v[108:111], v[144:147], v[44:47], v[108:111]
    buffer_load_dwordx4 a[12:15], v6, s[40:43], s27 offen offset:3072
    s_waitcnt lgkmcnt(6)
    v_mfma_f32_16x16x32_bf16 v[64:67], a[148:151], v[48:51], v[64:67]
    ds_read_b64_tr_b16 v[32:33], v244 offset:24576
    ds_read_b64_tr_b16 v[34:35], v244 offset:25088
    s_waitcnt lgkmcnt(6)
    v_mfma_f32_16x16x32_bf16 v[68:71], a[148:151], v[52:55], v[68:71]
    ds_read_b64_tr_b16 v[36:37], v245 offset:24576
    ds_read_b64_tr_b16 v[38:39], v245 offset:25088
    s_waitcnt lgkmcnt(6)
    v_mfma_f32_16x16x32_bf16 v[72:75], a[148:151], v[56:59], v[72:75]
    ds_read_b64_tr_b16 v[40:41], v246 offset:24576
    ds_read_b64_tr_b16 v[42:43], v246 offset:25088
    s_waitcnt lgkmcnt(6)
    v_mfma_f32_16x16x32_bf16 v[76:79], a[148:151], v[60:63], v[76:79]
    ds_read_b64_tr_b16 v[44:45], v247 offset:24576
    ds_read_b64_tr_b16 v[46:47], v247 offset:25088
    s_add_u32 s27, s27, 4096
    buffer_load_dwordx4 a[16:19], v6, s[40:43], s27 offen offset:0
    v_mfma_f32_16x16x32_bf16 v[80:83], a[212:215], v[48:51], v[80:83]
    v_mfma_f32_16x16x32_bf16 v[84:87], a[212:215], v[52:55], v[84:87]
    v_mfma_f32_16x16x32_bf16 v[88:91], a[212:215], v[56:59], v[88:91]
    v_mfma_f32_16x16x32_bf16 v[92:95], a[212:215], v[60:63], v[92:95]
    buffer_load_dwordx4 a[20:23], v6, s[40:43], s27 offen offset:1024
    v_mfma_f32_16x16x32_bf16 v[96:99], v[148:151], v[48:51], v[96:99]
    v_mfma_f32_16x16x32_bf16 v[100:103], v[148:151], v[52:55], v[100:103]
    v_mfma_f32_16x16x32_bf16 v[104:107], v[148:151], v[56:59], v[104:107]
    v_mfma_f32_16x16x32_bf16 v[108:111], v[148:151], v[60:63], v[108:111]
    buffer_load_dwordx4 a[24:27], v6, s[40:43], s27 offen offset:2048
    s_waitcnt lgkmcnt(6)
    v_mfma_f32_16x16x32_bf16 v[64:67], a[152:155], v[32:35], v[64:67]
    ds_read_b64_tr_b16 v[48:49], v244 offset:28672
    ds_read_b64_tr_b16 v[50:51], v244 offset:29184
    s_waitcnt lgkmcnt(6)
    v_mfma_f32_16x16x32_bf16 v[68:71], a[152:155], v[36:39], v[68:71]
    ds_read_b64_tr_b16 v[52:53], v245 offset:28672
    ds_read_b64_tr_b16 v[54:55], v245 offset:29184
    s_waitcnt lgkmcnt(6)
    v_mfma_f32_16x16x32_bf16 v[72:75], a[152:155], v[40:43], v[72:75]
    ds_read_b64_tr_b16 v[56:57], v246 offset:28672
    ds_read_b64_tr_b16 v[58:59], v246 offset:29184
    s_waitcnt lgkmcnt(6)
    v_mfma_f32_16x16x32_bf16 v[76:79], a[152:155], v[44:47], v[76:79]
    ds_read_b64_tr_b16 v[60:61], v247 offset:28672
    ds_read_b64_tr_b16 v[62:63], v247 offset:29184
    buffer_load_dwordx4 a[28:31], v6, s[40:43], s27 offen offset:3072
    v_mfma_f32_16x16x32_bf16 v[80:83], a[216:219], v[32:35], v[80:83]
    v_mfma_f32_16x16x32_bf16 v[84:87], a[216:219], v[36:39], v[84:87]
    v_mfma_f32_16x16x32_bf16 v[88:91], a[216:219], v[40:43], v[88:91]
    v_mfma_f32_16x16x32_bf16 v[92:95], a[216:219], v[44:47], v[92:95]
    s_add_u32 s27, s27, 4096
    buffer_load_dwordx4 a[32:35], v6, s[40:43], s27 offen offset:0
    v_mfma_f32_16x16x32_bf16 v[96:99], v[152:155], v[32:35], v[96:99]
    v_mfma_f32_16x16x32_bf16 v[100:103], v[152:155], v[36:39], v[100:103]
    v_mfma_f32_16x16x32_bf16 v[104:107], v[152:155], v[40:43], v[104:107]
    v_mfma_f32_16x16x32_bf16 v[108:111], v[152:155], v[44:47], v[108:111]
    buffer_load_dwordx4 a[36:39], v6, s[40:43], s27 offen offset:1024
    s_waitcnt lgkmcnt(6)
    v_mfma_f32_16x16x32_bf16 v[64:67], a[156:159], v[48:51], v[64:67]
    s_waitcnt vmcnt(17)
    s_barrier
    s_waitcnt lgkmcnt(4)
    v_mfma_f32_16x16x32_bf16 v[68:71], a[156:159], v[52:55], v[68:71]
    ds_read_b64_tr_b16 v[32:33], v244 offset:32768
    ds_read_b64_tr_b16 v[34:35], v244 offset:33280
    s_waitcnt lgkmcnt(4)
    v_mfma_f32_16x16x32_bf16 v[72:75], a[156:159], v[56:59], v[72:75]
    ds_read_b64_tr_b16 v[36:37], v245 offset:32768
    ds_read_b64_tr_b16 v[38:39], v245 offset:33280
    s_waitcnt lgkmcnt(4)
    v_mfma_f32_16x16x32_bf16 v[76:79], a[156:159], v[60:63], v[76:79]
    ds_read_b64_tr_b16 v[40:41], v246 offset:32768
    ds_read_b64_tr_b16 v[42:43], v246 offset:33280
    buffer_load_dwordx4 a[40:43], v6, s[40:43], s27 offen offset:2048
    v_mfma_f32_16x16x32_bf16 v[80:83], a[220:223], v[48:51], v[80:83]
    ds_read_b64_tr_b16 v[44:45], v247 offset:32768
    ds_read_b64_tr_b16 v[46:47], v247 offset:33280
    v_mfma_f32_16x16x32_bf16 v[84:87], a[220:223], v[52:55], v[84:87]
    v_mfma_f32_16x16x32_bf16 v[88:91], a[220:223], v[56:59], v[88:91]
    v_mfma_f32_16x16x32_bf16 v[92:95], a[220:223], v[60:63], v[92:95]
    buffer_load_dwordx4 a[44:47], v6, s[40:43], s27 offen offset:3072
    v_mfma_f32_16x16x32_bf16 v[96:99], v[156:159], v[48:51], v[96:99]
    v_mfma_f32_16x16x32_bf16 v[100:103], v[156:159], v[52:55], v[100:103]
    v_mfma_f32_16x16x32_bf16 v[104:107], v[156:159], v[56:59], v[104:107]
    v_mfma_f32_16x16x32_bf16 v[108:111], v[156:159], v[60:63], v[108:111]
    s_add_u32 s27, s27, 4096
    buffer_load_dwordx4 a[48:51], v6, s[40:43], s27 offen offset:0
    s_waitcnt lgkmcnt(6)
    v_mfma_f32_16x16x32_bf16 v[64:67], a[160:163], v[32:35], v[64:67]
    ds_read_b64_tr_b16 v[48:49], v244 offset:36864
    ds_read_b64_tr_b16 v[50:51], v244 offset:37376
    s_waitcnt lgkmcnt(6)
    v_mfma_f32_16x16x32_bf16 v[68:71], a[160:163], v[36:39], v[68:71]
    ds_read_b64_tr_b16 v[52:53], v245 offset:36864
    ds_read_b64_tr_b16 v[54:55], v245 offset:37376
    s_waitcnt lgkmcnt(6)
    v_mfma_f32_16x16x32_bf16 v[72:75], a[160:163], v[40:43], v[72:75]
    ds_read_b64_tr_b16 v[56:57], v246 offset:36864
    ds_read_b64_tr_b16 v[58:59], v246 offset:37376
    s_waitcnt lgkmcnt(6)
    v_mfma_f32_16x16x32_bf16 v[76:79], a[160:163], v[44:47], v[76:79]
    ds_read_b64_tr_b16 v[60:61], v247 offset:36864
    ds_read_b64_tr_b16 v[62:63], v247 offset:37376
    buffer_load_dwordx4 a[52:55], v6, s[40:43], s27 offen offset:1024
    v_mfma_f32_16x16x32_bf16 v[80:83], a[224:227], v[32:35], v[80:83]
    v_mfma_f32_16x16x32_bf16 v[84:87], a[224:227], v[36:39], v[84:87]
    v_mfma_f32_16x16x32_bf16 v[88:91], a[224:227], v[40:43], v[88:91]
    v_mfma_f32_16x16x32_bf16 v[92:95], a[224:227], v[44:47], v[92:95]
    buffer_load_dwordx4 a[56:59], v6, s[40:43], s27 offen offset:2048
    v_mfma_f32_16x16x32_bf16 v[96:99], v[160:163], v[32:35], v[96:99]
    v_mfma_f32_16x16x32_bf16 v[100:103], v[160:163], v[36:39], v[100:103]
    v_mfma_f32_16x16x32_bf16 v[104:107], v[160:163], v[40:43], v[104:107]
    v_mfma_f32_16x16x32_bf16 v[108:111], v[160:163], v[44:47], v[108:111]
    buffer_load_dwordx4 a[60:63], v6, s[40:43], s27 offen offset:3072
    s_waitcnt lgkmcnt(6)
    v_mfma_f32_16x16x32_bf16 v[64:67], a[164:167], v[48:51], v[64:67]
    ds_read_b64_tr_b16 v[32:33], v244 offset:40960
    ds_read_b64_tr_b16 v[34:35], v244 offset:41472
    s_waitcnt lgkmcnt(6)
    v_mfma_f32_16x16x32_bf16 v[68:71], a[164:167], v[52:55], v[68:71]
    ds_read_b64_tr_b16 v[36:37], v245 offset:40960
    ds_read_b64_tr_b16 v[38:39], v245 offset:41472
    s_waitcnt lgkmcnt(6)
    v_mfma_f32_16x16x32_bf16 v[72:75], a[164:167], v[56:59], v[72:75]
    ds_read_b64_tr_b16 v[40:41], v246 offset:40960
    ds_read_b64_tr_b16 v[42:43], v246 offset:41472
    s_waitcnt lgkmcnt(6)
    v_mfma_f32_16x16x32_bf16 v[76:79], a[164:167], v[60:63], v[76:79]
    ds_read_b64_tr_b16 v[44:45], v247 offset:40960
    ds_read_b64_tr_b16 v[46:47], v247 offset:41472
    s_add_u32 s27, s27, 4096
    buffer_load_dwordx4 a[64:67], v6, s[40:43], s27 offen offset:0
    v_mfma_f32_16x16x32_bf16 v[80:83], a[228:231], v[48:51], v[80:83]
    buffer_load_dwordx4 v[208:211], v241, s[40:43], s20 offen offset:0 sc1
    buffer_load_dwordx4 v[212:215], v241, s[40:43], s20 offen offset:1024 sc1
    v_mfma_f32_16x16x32_bf16 v[84:87], a[228:231], v[52:55], v[84:87]
    buffer_load_dwordx4 v[216:219], v241, s[40:43], s20 offen offset:2048 sc1
    buffer_load_dwordx4 v[220:223], v241, s[40:43], s20 offen offset:3072 sc1
    v_mfma_f32_16x16x32_bf16 v[88:91], a[228:231], v[56:59], v[88:91]
    buffer_load_dwordx4 v[224:227], v241, s[40:43], s21 offen offset:0 sc1
    buffer_load_dwordx4 v[228:231], v241, s[40:43], s21 offen offset:1024 sc1
    v_mfma_f32_16x16x32_bf16 v[92:95], a[228:231], v[60:63], v[92:95]
    buffer_load_dwordx4 v[232:235], v241, s[40:43], s21 offen offset:2048 sc1
    buffer_load_dwordx4 v[236:239], v241, s[40:43], s21 offen offset:3072 sc1
    buffer_load_dwordx4 a[68:71], v6, s[40:43], s27 offen offset:1024
    v_mfma_f32_16x16x32_bf16 v[96:99], v[164:167], v[48:51], v[96:99]
    v_mfma_f32_16x16x32_bf16 v[100:103], v[164:167], v[52:55], v[100:103]
    v_mfma_f32_16x16x32_bf16 v[104:107], v[164:167], v[56:59], v[104:107]
    v_mfma_f32_16x16x32_bf16 v[108:111], v[164:167], v[60:63], v[108:111]
    buffer_load_dwordx4 a[72:75], v6, s[40:43], s27 offen offset:2048
    s_waitcnt lgkmcnt(6)
    v_mfma_f32_16x16x32_bf16 v[64:67], a[168:171], v[32:35], v[64:67]
    ds_read_b64_tr_b16 v[48:49], v244 offset:45056
    ds_read_b64_tr_b16 v[50:51], v244 offset:45568
    s_waitcnt lgkmcnt(6)
    v_mfma_f32_16x16x32_bf16 v[68:71], a[168:171], v[36:39], v[68:71]
    ds_read_b64_tr_b16 v[52:53], v245 offset:45056
    ds_read_b64_tr_b16 v[54:55], v245 offset:45568
    s_waitcnt lgkmcnt(6)
    v_mfma_f32_16x16x32_bf16 v[72:75], a[168:171], v[40:43], v[72:75]
    ds_read_b64_tr_b16 v[56:57], v246 offset:45056
    ds_read_b64_tr_b16 v[58:59], v246 offset:45568
    s_waitcnt lgkmcnt(6)
    v_mfma_f32_16x16x32_bf16 v[76:79], a[168:171], v[44:47], v[76:79]
    ds_read_b64_tr_b16 v[60:61], v247 offset:45056
    ds_read_b64_tr_b16 v[62:63], v247 offset:45568
    buffer_load_dwordx4 a[76:79], v6, s[40:43], s27 offen offset:3072
    v_mfma_f32_16x16x32_bf16 v[80:83], a[232:235], v[32:35], v[80:83]
    v_mfma_f32_16x16x32_bf16 v[84:87], a[232:235], v[36:39], v[84:87]
    v_mfma_f32_16x16x32_bf16 v[88:91], a[232:235], v[40:43], v[88:91]
    v_mfma_f32_16x16x32_bf16 v[92:95], a[232:235], v[44:47], v[92:95]
    s_add_u32 s27, s27, 4096
    buffer_load_dwordx4 a[80:83], v6, s[40:43], s27 offen offset:0
    v_mfma_f32_16x16x32_bf16 v[96:99], v[168:171], v[32:35], v[96:99]
    v_mfma_f32_16x16x32_bf16 v[100:103], v[168:171], v[36:39], v[100:103]
    v_mfma_f32_16x16x32_bf16 v[104:107], v[168:171], v[40:43], v[104:107]
    v_mfma_f32_16x16x32_bf16 v[108:111], v[168:171], v[44:47], v[108:111]
    buffer_load_dwordx4 a[84:87], v6, s[40:43], s27 offen offset:1024
    s_waitcnt lgkmcnt(6)
    v_mfma_f32_16x16x32_bf16 v[64:67], a[172:175], v[48:51], v[64:67]
    s_waitcnt vmcnt(33)
    s_barrier
    s_waitcnt lgkmcnt(4)
    v_mfma_f32_16x16x32_bf16 v[68:71], a[172:175], v[52:55], v[68:71]
    ds_read_b64_tr_b16 v[32:33], v244 offset:49152
    ds_read_b64_tr_b16 v[34:35], v244 offset:49664
    s_waitcnt lgkmcnt(4)
    v_mfma_f32_16x16x32_bf16 v[72:75], a[172:175], v[56:59], v[72:75]
    ds_read_b64_tr_b16 v[36:37], v245 offset:49152
    ds_read_b64_tr_b16 v[38:39], v245 offset:49664
    s_waitcnt lgkmcnt(4)
    v_mfma_f32_16x16x32_bf16 v[76:79], a[172:175], v[60:63], v[76:79]
    ds_read_b64_tr_b16 v[40:41], v246 offset:49152
    ds_read_b64_tr_b16 v[42:43], v246 offset:49664
    buffer_load_dwordx4 a[88:91], v6, s[40:43], s27 offen offset:2048
    v_mfma_f32_16x16x32_bf16 v[80:83], a[236:239], v[48:51], v[80:83]
    ds_read_b64_tr_b16 v[44:45], v247 offset:49152
    ds_read_b64_tr_b16 v[46:47], v247 offset:49664
    v_mfma_f32_16x16x32_bf16 v[84:87], a[236:239], v[52:55], v[84:87]
    v_mfma_f32_16x16x32_bf16 v[88:91], a[236:239], v[56:59], v[88:91]
    v_mfma_f32_16x16x32_bf16 v[92:95], a[236:239], v[60:63], v[92:95]
    buffer_load_dwordx4 a[92:95], v6, s[40:43], s27 offen offset:3072
    v_mfma_f32_16x16x32_bf16 v[96:99], v[172:175], v[48:51], v[96:99]
    v_mfma_f32_16x16x32_bf16 v[100:103], v[172:175], v[52:55], v[100:103]
    v_mfma_f32_16x16x32_bf16 v[104:107], v[172:175], v[56:59], v[104:107]
    v_mfma_f32_16x16x32_bf16 v[108:111], v[172:175], v[60:63], v[108:111]
    s_add_u32 s27, s27, 4096
    buffer_load_dwordx4 a[96:99], v6, s[40:43], s27 offen offset:0
    s_waitcnt lgkmcnt(6)
    v_mfma_f32_16x16x32_bf16 v[64:67], a[176:179], v[32:35], v[64:67]
    ds_read_b64_tr_b16 v[48:49], v244 offset:53248
    ds_read_b64_tr_b16 v[50:51], v244 offset:53760
    s_waitcnt lgkmcnt(6)
    v_mfma_f32_16x16x32_bf16 v[68:71], a[176:179], v[36:39], v[68:71]
    ds_read_b64_tr_b16 v[52:53], v245 offset:53248
    ds_read_b64_tr_b16 v[54:55], v245 offset:53760
    s_waitcnt lgkmcnt(6)
    v_mfma_f32_16x16x32_bf16 v[72:75], a[176:179], v[40:43], v[72:75]
    ds_read_b64_tr_b16 v[56:57], v246 offset:53248
    ds_read_b64_tr_b16 v[58:59], v246 offset:53760
    s_waitcnt lgkmcnt(6)
    v_mfma_f32_16x16x32_bf16 v[76:79], a[176:179], v[44:47], v[76:79]
    ds_read_b64_tr_b16 v[60:61], v247 offset:53248
    ds_read_b64_tr_b16 v[62:63], v247 offset:53760
    buffer_load_dwordx4 a[100:103], v6, s[40:43], s27 offen offset:1024
    v_mfma_f32_16x16x32_bf16 v[80:83], a[240:243], v[32:35], v[80:83]
    v_mfma_f32_16x16x32_bf16 v[84:87], a[240:243], v[36:39], v[84:87]
    v_mfma_f32_16x16x32_bf16 v[88:91], a[240:243], v[40:43], v[88:91]
    v_mfma_f32_16x16x32_bf16 v[92:95], a[240:243], v[44:47], v[92:95]
    buffer_load_dwordx4 a[104:107], v6, s[40:43], s27 offen offset:2048
    v_mfma_f32_16x16x32_bf16 v[96:99], v[176:179], v[32:35], v[96:99]
    v_mfma_f32_16x16x32_bf16 v[100:103], v[176:179], v[36:39], v[100:103]
    v_mfma_f32_16x16x32_bf16 v[104:107], v[176:179], v[40:43], v[104:107]
    v_mfma_f32_16x16x32_bf16 v[108:111], v[176:179], v[44:47], v[108:111]
    s_waitcnt lgkmcnt(6)
    v_mfma_f32_16x16x32_bf16 v[64:67], a[180:183], v[48:51], v[64:67]
    ds_read_b64_tr_b16 v[32:33], v244 offset:57344
    ds_read_b64_tr_b16 v[34:35], v244 offset:57856
    s_waitcnt lgkmcnt(6)
    v_mfma_f32_16x16x32_bf16 v[68:71], a[180:183], v[52:55], v[68:71]
    ds_read_b64_tr_b16 v[36:37], v245 offset:57344
    ds_read_b64_tr_b16 v[38:39], v245 offset:57856
    s_waitcnt lgkmcnt(6)
    v_mfma_f32_16x16x32_bf16 v[72:75], a[180:183], v[56:59], v[72:75]
    ds_read_b64_tr_b16 v[40:41], v246 offset:57344
    ds_read_b64_tr_b16 v[42:43], v246 offset:57856
    s_waitcnt lgkmcnt(6)
    v_mfma_f32_16x16x32_bf16 v[76:79], a[180:183], v[60:63], v[76:79]
    ds_read_b64_tr_b16 v[44:45], v247 offset:57344
    ds_read_b64_tr_b16 v[46:47], v247 offset:57856
    v_mfma_f32_16x16x32_bf16 v[80:83], a[244:247], v[48:51], v[80:83]
    s_mov_b32 s7, 0
    s_nop 6
DS8:
    s_waitcnt vmcnt(17)
    v_xor_b32 v7, s60, v209
    v_xor_b32 v242, s60, v211
    v_or_b32 v7, v7, v242
    s_waitcnt vmcnt(16)
    v_xor_b32 v242, s60, v213
    v_or_b32 v7, v7, v242
    v_xor_b32 v242, s60, v215
    v_or_b32 v7, v7, v242
    s_waitcnt vmcnt(15)
    v_xor_b32 v242, s60, v217
    v_or_b32 v7, v7, v242
    v_xor_b32 v242, s60, v219
    v_or_b32 v7, v7, v242
    s_waitcnt vmcnt(14)
    v_xor_b32 v242, s60, v221
    v_or_b32 v7, v7, v242
    v_xor_b32 v242, s60, v223
    v_or_b32 v7, v7, v242
    s_waitcnt vmcnt(13)
    v_xor_b32 v242, s60, v225
    v_or_b32 v7, v7, v242
    v_xor_b32 v242, s60, v227
    v_or_b32 v7, v7, v242
    s_waitcnt vmcnt(12)
    v_xor_b32 v242, s60, v229
    v_or_b32 v7, v7, v242
    v_xor_b32 v242, s60, v231
    v_or_b32 v7, v7, v242
    s_waitcnt vmcnt(11)
    v_xor_b32 v242, s60, v233
    v_or_b32 v7, v7, v242
    v_xor_b32 v242, s60, v235
    v_or_b32 v7, v7, v242
    s_waitcnt vmcnt(10)
    v_xor_b32 v242, s60, v237
    v_or_b32 v7, v7, v242
    v_xor_b32 v242, s60, v239
    v_or_b32 v7, v7, v242
    v_cmp_ne_u32 vcc, 0, v7
    s_add_u32 s7, s7, 1
    s_cmp_gt_u32 s7, 20000
    s_cselect_b64 vcc, 0, vcc
    s_cmp_eq_u64 vcc, 0
    s_nop 0
    s_cbranch_scc1 DS8D
    buffer_load_dwordx4 v[208:211], v241, s[40:43], s20 offen offset:0 sc1
    buffer_load_dwordx4 v[212:215], v241, s[40:43], s20 offen offset:1024 sc1
    buffer_load_dwordx4 v[216:219], v241, s[40:43], s20 offen offset:2048 sc1
    buffer_load_dwordx4 v[220:223], v241, s[40:43], s20 offen offset:3072 sc1
    buffer_load_dwordx4 v[224:227], v241, s[40:43], s21 offen offset:0 sc1
    buffer_load_dwordx4 v[228:231], v241, s[40:43], s21 offen offset:1024 sc1
    buffer_load_dwordx4 v[232:235], v241, s[40:43], s21 offen offset:2048 sc1
    buffer_load_dwordx4 v[236:239], v241, s[40:43], s21 offen offset:3072 sc1
    s_waitcnt vmcnt(0)
    s_nop 0
    s_branch DS8
    s_nop 0
DS8D:
    v_mfma_f32_16x16x32_bf16 v[84:87], a[244:247], v[52:55], v[84:87]
    v_mfma_f32_16x16x32_bf16 v[88:91], a[244:247], v[56:59], v[88:91]
    v_mfma_f32_16x16x32_bf16 v[92:95], a[244:247], v[60:63], v[92:95]
    v_mfma_f32_16x16x32_bf16 v[96:99], v[180:183], v[48:51], v[96:99]
    v_mfma_f32_16x16x32_bf16 v[100:103], v[180:183], v[52:55], v[100:103]
    v_mfma_f32_16x16x32_bf16 v[104:107], v[180:183], v[56:59], v[104:107]
    v_mfma_f32_16x16x32_bf16 v[108:111], v[180:183], v[60:63], v[108:111]
    s_waitcnt lgkmcnt(6)
    v_mfma_f32_16x16x32_bf16 v[64:67], a[184:187], v[32:35], v[64:67]
    ds_read_b64_tr_b16 v[48:49], v244 offset:61440
    ds_read_b64_tr_b16 v[50:51], v244 offset:61952
    ds_read_b64_tr_b16 v[52:53], v245 offset:61440
    ds_read_b64_tr_b16 v[54:55], v245 offset:61952
    ds_read_b64_tr_b16 v[56:57], v246 offset:61440
    ds_read_b64_tr_b16 v[58:59], v246 offset:61952
    s_waitcnt lgkmcnt(10)
    v_mfma_f32_16x16x32_bf16 v[68:71], a[184:187], v[36:39], v[68:71]
    ds_read_b64_tr_b16 v[60:61], v247 offset:61440
    ds_read_b64_tr_b16 v[62:63], v247 offset:61952
    v_add_f32 v120, v208, v212
    v_add_f32 v120, v120, v216
    v_add_f32 v120, v120, v220
    v_add_f32 v120, v120, v224
    s_waitcnt lgkmcnt(10)
    v_mfma_f32_16x16x32_bf16 v[72:75], a[184:187], v[40:43], v[72:75]
    v_add_f32 v120, v120, v228
    v_add_f32 v120, v120, v232
    v_add_f32 v120, v120, v236
    v_add_f32 v124, v210, v214
    v_add_f32 v124, v124, v218
    v_add_f32 v124, v124, v222
    s_waitcnt lgkmcnt(8)
    v_mfma_f32_16x16x32_bf16 v[76:79], a[184:187], v[44:47], v[76:79]
    v_add_f32 v124, v124, v226
    v_add_f32 v124, v124, v230
    v_add_f32 v124, v124, v234
    v_add_f32 v124, v124, v238
    s_mov_b32 s3, 0x3b000000
    v_mul_f32 v124, s3, v124
    v_mfma_f32_16x16x32_bf16 v[80:83], a[248:251], v[32:35], v[80:83]
    v_mul_f32 v120, s3, v120
    v_fma_f32 v120, -v124, v124, v120
    v_max_f32 v120, 0, v120
    v_cvt_pk_bf16_f32 v120, 0, v120
    v_add_f32 v120, 0x3727c5ac, v120
    v_cvt_pk_bf16_f32 v120, 0, v120
    v_mfma_f32_16x16x32_bf16 v[84:87], a[248:251], v[36:39], v[84:87]
    v_sqrt_f32 v120, v120
    s_nop 0
    v_cvt_pk_bf16_f32 v120, 0, v120
    v_rcp_f32 v120, v120
    v_cvt_pk_bf16_f32 v124, 0, v124
    v_mul_f32 v121, -v124, v120
    v_and_b32 v241, 15, v0
    v_mfma_f32_16x16x32_bf16 v[88:91], a[248:251], v[40:43], v[88:91]
    s_lshl_b32 s3, s4, 7
    s_add_u32 s3, s3, 131072
    v_lshl_add_u32 v7, v241, 3, s3
    s_mov_b32 s6, 0x00f0000f
    s_mov_b32 s7, 0xf0000f00
    s_mov_b64 exec, s[6:7]
    ds_write_b64 v7, v[120:121]
    s_mov_b64 exec, -1
    v_mfma_f32_16x16x32_bf16 v[92:95], a[248:251], v[44:47], v[92:95]
    s_waitcnt lgkmcnt(0)
    s_barrier
    s_add_u32 s3, s4, 0
    s_and_b32 s3, s3, 3
    s_lshl_b32 s3, s3, 7
    s_add_u32 s3, s3, 131072
    v_lshl_add_u32 v7, v241, 3, s3
    v_mfma_f32_16x16x32_bf16 v[96:99], v[184:187], v[32:35], v[96:99]
    ds_read_b64 v[112:113], v7
    s_add_u32 s3, s4, 1
    s_and_b32 s3, s3, 3
    s_lshl_b32 s3, s3, 7
    s_add_u32 s3, s3, 131072
    v_lshl_add_u32 v7, v241, 3, s3
    v_mfma_f32_16x16x32_bf16 v[100:103], v[184:187], v[36:39], v[100:103]
    ds_read_b64 v[114:115], v7
    s_add_u32 s3, s4, 2
    s_and_b32 s3, s3, 3
    s_lshl_b32 s3, s3, 7
    s_add_u32 s3, s3, 131072
    v_lshl_add_u32 v7, v241, 3, s3
    v_mfma_f32_16x16x32_bf16 v[104:107], v[184:187], v[40:43], v[104:107]
    ds_read_b64 v[116:117], v7
    s_add_u32 s3, s4, 3
    s_and_b32 s3, s3, 3
    s_lshl_b32 s3, s3, 7
    s_add_u32 s3, s3, 131072
    v_lshl_add_u32 v7, v241, 3, s3
    v_mfma_f32_16x16x32_bf16 v[108:111], v[184:187], v[44:47], v[108:111]
    ds_read_b64 v[118:119], v7
    v_mfma_f32_16x16x32_bf16 v[64:67], a[188:191], v[48:51], v[64:67]
    v_mfma_f32_16x16x32_bf16 v[68:71], a[188:191], v[52:55], v[68:71]
    v_mfma_f32_16x16x32_bf16 v[72:75], a[188:191], v[56:59], v[72:75]
    v_mfma_f32_16x16x32_bf16 v[76:79], a[188:191], v[60:63], v[76:79]
    v_mfma_f32_16x16x32_bf16 v[80:83], a[252:255], v[48:51], v[80:83]
    v_mfma_f32_16x16x32_bf16 v[84:87], a[252:255], v[52:55], v[84:87]
    v_mfma_f32_16x16x32_bf16 v[88:91], a[252:255], v[56:59], v[88:91]
    v_mfma_f32_16x16x32_bf16 v[92:95], a[252:255], v[60:63], v[92:95]
    v_mfma_f32_16x16x32_bf16 v[96:99], v[188:191], v[48:51], v[96:99]
    v_mfma_f32_16x16x32_bf16 v[100:103], v[188:191], v[52:55], v[100:103]
    v_mfma_f32_16x16x32_bf16 v[104:107], v[188:191], v[56:59], v[104:107]
    v_mfma_f32_16x16x32_bf16 v[108:111], v[188:191], v[60:63], v[108:111]
    s_mul_i32 s16, s8, 44
    s_mul_i32 s17, s4, 11
    s_add_u32 s17, s17, s9
    s_add_u32 s17, s17, s16
    s_lshl_b32 s17, s17, 12
    s_add_u32 s17, s17, 10485760
    s_and_b32 s19, s14, 3
    s_mul_i32 s19, s19, 11
    s_lshr_b32 s3, s14, 2
    s_add_u32 s19, s19, s3
    s_add_u32 s19, s19, s16
    s_lshl_b32 s19, s19, 12
    s_and_b32 s3, s4, 1
    s_lshl_b32 s3, s3, 11
    s_add_u32 s19, s19, s3
    s_add_u32 s19, s19, 10485760
    s_cmp_lt_u32 s14, 43
    s_cselect_b32 s19, s19, 0x7ff00000
    s_add_u32 s3, s4, 0
    s_and_b32 s3, s3, 3
    s_lshl_b32 s3, s3, 10
    v_add_u32 v244, s3, v6
    v_lshrrev_b32 v240, 1, v244
    s_add_u32 s3, s4, 1
    s_and_b32 s3, s3, 3
    s_lshl_b32 s3, s3, 10
    v_add_u32 v245, s3, v6
    v_lshrrev_b32 v241, 1, v245
    s_add_u32 s3, s4, 2
    s_and_b32 s3, s3, 3
    s_lshl_b32 s3, s3, 10
    v_add_u32 v246, s3, v6
    v_lshrrev_b32 v242, 1, v246
    s_add_u32 s3, s4, 3
    s_and_b32 s3, s3, 3
    s_lshl_b32 s3, s3, 10
    v_add_u32 v247, s3, v6
    v_lshrrev_b32 v243, 1, v247
    s_waitcnt lgkmcnt(3)
    v_pk_fma_f32 v[120:121], v[8:9], v[112:113], v[20:21] op_sel:[0,1,0] op_sel_hi:[1,1,1]
    v_pk_fma_f32 v[124:125], v[12:13], v[112:113], v[24:25] op_sel:[0,1,0] op_sel_hi:[1,1,1]
    v_pk_fma_f32 v[248:249], v[16:17], v[112:113], v[28:29] op_sel:[0,1,0] op_sel_hi:[1,1,1]
    v_pk_fma_f32 v[122:123], v[10:11], v[112:113], v[22:23] op_sel:[0,1,0] op_sel_hi:[1,1,1]
    v_pk_fma_f32 v[126:127], v[14:15], v[112:113], v[26:27] op_sel:[0,1,0] op_sel_hi:[1,1,1]
    v_pk_fma_f32 v[250:251], v[18:19], v[112:113], v[30:31] op_sel:[0,1,0] op_sel_hi:[1,1,1]
    v_pk_fma_f32 v[64:65], v[64:65], v[112:113], v[120:121] op_sel:[0,0,0] op_sel_hi:[1,0,1]
    v_pk_fma_f32 v[80:81], v[80:81], v[112:113], v[124:125] op_sel:[0,0,0] op_sel_hi:[1,0,1]
    v_pk_fma_f32 v[96:97], v[96:97], v[112:113], v[248:249] op_sel:[0,0,0] op_sel_hi:[1,0,1]
    v_pk_fma_f32 v[66:67], v[66:67], v[112:113], v[122:123] op_sel:[0,0,0] op_sel_hi:[1,0,1]
    v_pk_fma_f32 v[82:83], v[82:83], v[112:113], v[126:127] op_sel:[0,0,0] op_sel_hi:[1,0,1]
    v_pk_fma_f32 v[98:99], v[98:99], v[112:113], v[250:251] op_sel:[0,0,0] op_sel_hi:[1,0,1]
    v_max_f32 v64, 0, v64
    v_max_f32 v80, 0, v80
    v_max_f32 v96, 0, v96
    v_max_f32 v65, 0, v65
    v_max_f32 v81, 0, v81
    v_max_f32 v97, 0, v97
    v_max_f32 v66, 0, v66
    v_max_f32 v82, 0, v82
    v_max_f32 v98, 0, v98
    v_max_f32 v67, 0, v67
    v_max_f32 v83, 0, v83
    v_max_f32 v99, 0, v99
    v_pk_mul_f32 v[64:65], v[64:65], v[64:65]
    v_pk_mul_f32 v[80:81], v[80:81], v[80:81]
    v_pk_mul_f32 v[96:97], v[96:97], v[96:97]
    v_pk_mul_f32 v[66:67], v[66:67], v[66:67]
    v_pk_mul_f32 v[82:83], v[82:83], v[82:83]
    v_pk_mul_f32 v[98:99], v[98:99], v[98:99]
    v_cvt_pk_bf16_f32 v32, v64, v65
    v_cvt_pk_bf16_f32 v34, v80, v81
    v_cvt_pk_bf16_f32 v36, v96, v97
    v_cvt_pk_bf16_f32 v33, v66, v67
    v_cvt_pk_bf16_f32 v35, v82, v83
    v_cvt_pk_bf16_f32 v37, v98, v99
    buffer_store_dwordx4 v[32:35], v244, s[40:43], s17 offen sc1
    buffer_store_dwordx2 v[36:37], v240, s[40:43], s19 offen sc1
    s_waitcnt lgkmcnt(2)
    v_pk_fma_f32 v[120:121], v[8:9], v[114:115], v[20:21] op_sel:[0,1,0] op_sel_hi:[1,1,1]
    v_pk_fma_f32 v[124:125], v[12:13], v[114:115], v[24:25] op_sel:[0,1,0] op_sel_hi:[1,1,1]
    v_pk_fma_f32 v[248:249], v[16:17], v[114:115], v[28:29] op_sel:[0,1,0] op_sel_hi:[1,1,1]
    v_pk_fma_f32 v[122:123], v[10:11], v[114:115], v[22:23] op_sel:[0,1,0] op_sel_hi:[1,1,1]
    v_pk_fma_f32 v[126:127], v[14:15], v[114:115], v[26:27] op_sel:[0,1,0] op_sel_hi:[1,1,1]
    v_pk_fma_f32 v[250:251], v[18:19], v[114:115], v[30:31] op_sel:[0,1,0] op_sel_hi:[1,1,1]
    v_pk_fma_f32 v[68:69], v[68:69], v[114:115], v[120:121] op_sel:[0,0,0] op_sel_hi:[1,0,1]
    v_pk_fma_f32 v[84:85], v[84:85], v[114:115], v[124:125] op_sel:[0,0,0] op_sel_hi:[1,0,1]
    v_pk_fma_f32 v[100:101], v[100:101], v[114:115], v[248:249] op_sel:[0,0,0] op_sel_hi:[1,0,1]
    v_pk_fma_f32 v[70:71], v[70:71], v[114:115], v[122:123] op_sel:[0,0,0] op_sel_hi:[1,0,1]
    v_pk_fma_f32 v[86:87], v[86:87], v[114:115], v[126:127] op_sel:[0,0,0] op_sel_hi:[1,0,1]
    v_pk_fma_f32 v[102:103], v[102:103], v[114:115], v[250:251] op_sel:[0,0,0] op_sel_hi:[1,0,1]
    v_max_f32 v68, 0, v68
    v_max_f32 v84, 0, v84
    v_max_f32 v100, 0, v100
    v_max_f32 v69, 0, v69
    v_max_f32 v85, 0, v85
    v_max_f32 v101, 0, v101
    v_max_f32 v70, 0, v70
    v_max_f32 v86, 0, v86
    v_max_f32 v102, 0, v102
    v_max_f32 v71, 0, v71
    v_max_f32 v87, 0, v87
    v_max_f32 v103, 0, v103
    v_pk_mul_f32 v[68:69], v[68:69], v[68:69]
    v_pk_mul_f32 v[84:85], v[84:85], v[84:85]
    v_pk_mul_f32 v[100:101], v[100:101], v[100:101]
    v_pk_mul_f32 v[70:71], v[70:71], v[70:71]
    v_pk_mul_f32 v[86:87], v[86:87], v[86:87]
    v_pk_mul_f32 v[102:103], v[102:103], v[102:103]
    v_cvt_pk_bf16_f32 v40, v68, v69
    v_cvt_pk_bf16_f32 v42, v84, v85
    v_cvt_pk_bf16_f32 v44, v100, v101
    v_cvt_pk_bf16_f32 v41, v70, v71
    v_cvt_pk_bf16_f32 v43, v86, v87
    v_cvt_pk_bf16_f32 v45, v102, v103
    buffer_store_dwordx4 v[40:43], v245, s[40:43], s17 offen sc1
    buffer_store_dwordx2 v[44:45], v241, s[40:43], s19 offen sc1
    s_waitcnt lgkmcnt(1)
    v_pk_fma_f32 v[120:121], v[8:9], v[116:117], v[20:21] op_sel:[0,1,0] op_sel_hi:[1,1,1]
    v_pk_fma_f32 v[124:125], v[12:13], v[116:117], v[24:25] op_sel:[0,1,0] op_sel_hi:[1,1,1]
    v_pk_fma_f32 v[248:249], v[16:17], v[116:117], v[28:29] op_sel:[0,1,0] op_sel_hi:[1,1,1]
    v_pk_fma_f32 v[122:123], v[10:11], v[116:117], v[22:23] op_sel:[0,1,0] op_sel_hi:[1,1,1]
    v_pk_fma_f32 v[126:127], v[14:15], v[116:117], v[26:27] op_sel:[0,1,0] op_sel_hi:[1,1,1]
    v_pk_fma_f32 v[250:251], v[18:19], v[116:117], v[30:31] op_sel:[0,1,0] op_sel_hi:[1,1,1]
    v_pk_fma_f32 v[72:73], v[72:73], v[116:117], v[120:121] op_sel:[0,0,0] op_sel_hi:[1,0,1]
    v_pk_fma_f32 v[88:89], v[88:89], v[116:117], v[124:125] op_sel:[0,0,0] op_sel_hi:[1,0,1]
    v_pk_fma_f32 v[104:105], v[104:105], v[116:117], v[248:249] op_sel:[0,0,0] op_sel_hi:[1,0,1]
    v_pk_fma_f32 v[74:75], v[74:75], v[116:117], v[122:123] op_sel:[0,0,0] op_sel_hi:[1,0,1]
    v_pk_fma_f32 v[90:91], v[90:91], v[116:117], v[126:127] op_sel:[0,0,0] op_sel_hi:[1,0,1]
    v_pk_fma_f32 v[106:107], v[106:107], v[116:117], v[250:251] op_sel:[0,0,0] op_sel_hi:[1,0,1]
    v_max_f32 v72, 0, v72
    v_max_f32 v88, 0, v88
    v_max_f32 v104, 0, v104
    v_max_f32 v73, 0, v73
    v_max_f32 v89, 0, v89
    v_max_f32 v105, 0, v105
    v_max_f32 v74, 0, v74
    v_max_f32 v90, 0, v90
    v_max_f32 v106, 0, v106
    v_max_f32 v75, 0, v75
    v_max_f32 v91, 0, v91
    v_max_f32 v107, 0, v107
    v_pk_mul_f32 v[72:73], v[72:73], v[72:73]
    v_pk_mul_f32 v[88:89], v[88:89], v[88:89]
    v_pk_mul_f32 v[104:105], v[104:105], v[104:105]
    v_pk_mul_f32 v[74:75], v[74:75], v[74:75]
    v_pk_mul_f32 v[90:91], v[90:91], v[90:91]
    v_pk_mul_f32 v[106:107], v[106:107], v[106:107]
    v_cvt_pk_bf16_f32 v48, v72, v73
    v_cvt_pk_bf16_f32 v50, v88, v89
    v_cvt_pk_bf16_f32 v52, v104, v105
    v_cvt_pk_bf16_f32 v49, v74, v75
    v_cvt_pk_bf16_f32 v51, v90, v91
    v_cvt_pk_bf16_f32 v53, v106, v107
    buffer_store_dwordx4 v[48:51], v246, s[40:43], s17 offen sc1
    buffer_store_dwordx2 v[52:53], v242, s[40:43], s19 offen sc1
    s_waitcnt lgkmcnt(0)
    v_pk_fma_f32 v[120:121], v[8:9], v[118:119], v[20:21] op_sel:[0,1,0] op_sel_hi:[1,1,1]
    v_pk_fma_f32 v[124:125], v[12:13], v[118:119], v[24:25] op_sel:[0,1,0] op_sel_hi:[1,1,1]
    v_pk_fma_f32 v[248:249], v[16:17], v[118:119], v[28:29] op_sel:[0,1,0] op_sel_hi:[1,1,1]
    v_pk_fma_f32 v[122:123], v[10:11], v[118:119], v[22:23] op_sel:[0,1,0] op_sel_hi:[1,1,1]
    v_pk_fma_f32 v[126:127], v[14:15], v[118:119], v[26:27] op_sel:[0,1,0] op_sel_hi:[1,1,1]
    v_pk_fma_f32 v[250:251], v[18:19], v[118:119], v[30:31] op_sel:[0,1,0] op_sel_hi:[1,1,1]
    v_pk_fma_f32 v[76:77], v[76:77], v[118:119], v[120:121] op_sel:[0,0,0] op_sel_hi:[1,0,1]
    v_pk_fma_f32 v[92:93], v[92:93], v[118:119], v[124:125] op_sel:[0,0,0] op_sel_hi:[1,0,1]
    v_pk_fma_f32 v[108:109], v[108:109], v[118:119], v[248:249] op_sel:[0,0,0] op_sel_hi:[1,0,1]
    v_pk_fma_f32 v[78:79], v[78:79], v[118:119], v[122:123] op_sel:[0,0,0] op_sel_hi:[1,0,1]
    v_pk_fma_f32 v[94:95], v[94:95], v[118:119], v[126:127] op_sel:[0,0,0] op_sel_hi:[1,0,1]
    v_pk_fma_f32 v[110:111], v[110:111], v[118:119], v[250:251] op_sel:[0,0,0] op_sel_hi:[1,0,1]
    v_max_f32 v76, 0, v76
    v_max_f32 v92, 0, v92
    v_max_f32 v108, 0, v108
    v_max_f32 v77, 0, v77
    v_max_f32 v93, 0, v93
    v_max_f32 v109, 0, v109
    v_max_f32 v78, 0, v78
    v_max_f32 v94, 0, v94
    v_max_f32 v110, 0, v110
    v_max_f32 v79, 0, v79
    v_max_f32 v95, 0, v95
    v_max_f32 v111, 0, v111
    v_pk_mul_f32 v[76:77], v[76:77], v[76:77]
    v_pk_mul_f32 v[92:93], v[92:93], v[92:93]
    v_pk_mul_f32 v[108:109], v[108:109], v[108:109]
    v_pk_mul_f32 v[78:79], v[78:79], v[78:79]
    v_pk_mul_f32 v[94:95], v[94:95], v[94:95]
    v_pk_mul_f32 v[110:111], v[110:111], v[110:111]
    v_cvt_pk_bf16_f32 v56, v76, v77
    v_cvt_pk_bf16_f32 v58, v92, v93
    v_cvt_pk_bf16_f32 v60, v108, v109
    v_cvt_pk_bf16_f32 v57, v78, v79
    v_cvt_pk_bf16_f32 v59, v94, v95
    v_cvt_pk_bf16_f32 v61, v110, v111
    buffer_store_dwordx4 v[56:59], v247, s[40:43], s17 offen sc1
    buffer_store_dwordx2 v[60:61], v243, s[40:43], s19 offen sc1
    s_and_b32 s8, s2, 31
    s_lshr_b32 s9, s2, 5
    s_waitcnt vmcnt(0)
    s_barrier
    s_cmp_lg_u32 s4, 0
    s_nop 0
    s_cbranch_scc1 SF9
    s_lshl_b32 s3, s2, 6
    s_add_u32 s3, s3, 22085632
    v_mov_b32 v56, s60
    v_mov_b32 v57, s61
    v_mov_b32 v58, 0
    s_mov_b64 exec, 1
    buffer_store_dwordx2 v[56:57], v58, s[40:43], s3 offen sc1
    s_mov_b64 exec, -1
    s_nop 1
SF9:
    buffer_load_dwordx4 a[108:111], v6, s[40:43], s27 offen offset:3072
    s_add_u32 s27, s27, 4096
    buffer_load_dwordx4 a[112:115], v6, s[40:43], s27 offen offset:0
    buffer_load_dwordx4 a[116:119], v6, s[40:43], s27 offen offset:1024
    buffer_load_dwordx4 a[120:123], v6, s[40:43], s27 offen offset:2048
    buffer_load_dwordx4 a[124:127], v6, s[40:43], s27 offen offset:3072
    s_add_u32 s27, s27, 4096
    buffer_load_dwordx4 v[192:195], v6, s[40:43], s27 offen offset:0
    buffer_load_dwordx4 v[196:199], v6, s[40:43], s27 offen offset:1024
    buffer_load_dwordx4 v[200:203], v6, s[40:43], s27 offen offset:2048
    buffer_load_dwordx4 v[204:207], v6, s[40:43], s27 offen offset:3072
    s_add_u32 s27, s27, 4096
    buffer_load_dwordx4 v[208:211], v6, s[40:43], s27 offen offset:0
    buffer_load_dwordx4 v[212:215], v6, s[40:43], s27 offen offset:1024
    buffer_load_dwordx4 v[216:219], v6, s[40:43], s27 offen offset:2048
    buffer_load_dwordx4 v[220:223], v6, s[40:43], s27 offen offset:3072
    s_add_u32 s27, s27, 4096
    s_cmp_eq_u32 s4, 3
    s_cselect_b32 s27, 0x7ff00000, s27
    buffer_load_dwordx4 v[224:227], v6, s[40:43], s27 offen offset:0
    buffer_load_dwordx4 v[228:231], v6, s[40:43], s27 offen offset:1024
    buffer_load_dwordx4 v[232:235], v6, s[40:43], s27 offen offset:2048
    buffer_load_dwordx4 v[236:239], v6, s[40:43], s27 offen offset:3072
    v_lshrrev_b32 v254, 2, v2
    v_lshl_add_u32 v254, v5, 3, v254
    s_lshr_b32 s3, s8, 3
    s_lshl_b32 s3, s3, 1
    s_and_b32 s6, s8, 7
    s_lshl_b32 s6, s6, 5
    s_add_u32 s3, s3, s6
    v_add_u32 v254, s3, v254
    v_lshlrev_b32 v254, 6, v254
    s_mov_b64 exec, 0xff
    s_mov_b32 s6, 22085632
    buffer_load_dwordx2 v[252:253], v254, s[40:43], s6 offen offset:0 sc1
    s_mov_b64 exec, -1
    s_lshl_b32 s3, s4, 9
    s_add_u32 s3, s3, 141824
    v_lshl_add_u32 v1, v3, 6, s3
    ds_read_b128 v[8:11], v1 offset:0
    ds_read_b128 v[24:27], v1 offset:256
    ds_read_b128 v[12:15], v1 offset:16
    ds_read_b128 v[28:31], v1 offset:272
    ds_read_b128 v[16:19], v1 offset:32
    ds_read_b128 v[32:35], v1 offset:288
    ds_read_b128 v[20:23], v1 offset:48
    ds_read_b128 v[36:39], v1 offset:304
    v_lshl_add_u32 v1, v3, 4, v4
    v_lshlrev_b32 v1, 7, v1
    v_lshl_add_u32 v1, v5, 3, v1
    s_mov_b32 s16, 0
    s_add_u32 s16, s16, 133632
    v_add_u32 v1, s16, v1
    v_lshrrev_b32 v7, 1, v4
    v_xor_b32 v7, s4, v7
    v_lshl_add_u32 v56, v7, 5, v1
    v_xor_b32 v7, 2, v7
    v_lshl_add_u32 v57, v7, 5, v1
    ds_read_b64_tr_b16 v[40:41], v56 offset:0
    ds_read_b64_tr_b16 v[42:43], v56 offset:512
    ds_read_b64_tr_b16 v[44:45], v57 offset:1024
    ds_read_b64_tr_b16 v[46:47], v57 offset:1536
    s_waitcnt lgkmcnt(3)
    v_lshlrev_b32 v48, 16, v40
    v_and_b32 v49, s5, v40
    v_lshlrev_b32 v50, 16, v41
    v_and_b32 v51, s5, v41
    s_waitcnt lgkmcnt(2)
    v_lshlrev_b32 v52, 16, v42
    v_and_b32 v53, s5, v42
    v_lshlrev_b32 v54, 16, v43
    v_and_b32 v55, s5, v43
    s_waitcnt lgkmcnt(1)
    v_lshlrev_b32 v56, 16, v44
    v_and_b32 v57, s5, v44
    v_lshlrev_b32 v58, 16, v45
    v_and_b32 v59, s5, v45
    s_waitcnt lgkmcnt(0)
    v_lshlrev_b32 v60, 16, v46
    v_and_b32 v61, s5, v46
    v_lshlrev_b32 v62, 16, v47
    v_and_b32 v63, s5, v47
    s_add_u32 s3, s4, 1
    s_and_b32 s3, s3, 3
    s_mul_i32 s3, s3, 12288
    s_add_u32 s3, s3, 0
    v_add_u32 v249, s3, v6
    s_add_u32 s3, s4, 2
    s_and_b32 s3, s3, 3
    s_mul_i32 s3, s3, 12288
    s_add_u32 s3, s3, 4096
    v_add_u32 v250, s3, v6
    s_add_u32 s3, s4, 3
    s_and_b32 s3, s3, 3
    s_mul_i32 s3, s3, 12288
    s_add_u32 s3, s3, 8192
    v_add_u32 v251, s3, v6
    s_mul_i32 s3, s4, 12288
    s_add_u32 s3, s3, 0
    v_add_u32 v248, s3, v6
    s_lshl_b32 s16, s8, 2
    s_add_u32 s16, s16, s4
    s_mul_i32 s16, s16, 45056
    s_add_u32 s16, s16, 10485760
    s_mov_b32 s44, s34
    s_mov_b32 s45, s35
    s_mov_b32 s46, 2097152
    s_mov_b32 s47, 0x20000
    v_and_b32 v1, 15, v0
    v_lshlrev_b32 v1, 17, v1
    v_lshl_add_u32 v1, v3, 5, v1
    s_lshl_b32 s17, s8, 2
    s_add_u32 s17, s17, s4
    s_lshl_b32 s17, s17, 10
    s_lshl_b32 s3, s9, 7
    s_add_u32 s17, s17, s3
    s_mov_b32 s7, 0
    s_nop 0
PL10:
    s_waitcnt vmcnt(0)
    v_cmp_ne_u64 vcc, s[60:61], v[252:253]
    s_nop 0
    s_and_b64 vcc, vcc, 0xff
    s_add_u32 s7, s7, 1
    s_cmp_gt_u32 s7, 20000
    s_cselect_b64 vcc, 0, vcc
    s_cmp_eq_u64 vcc, 0
    s_nop 0
    s_cbranch_scc1 PL10D
    s_mov_b64 exec, 0xff
    s_mov_b32 s6, 22085632
    buffer_load_dwordx2 v[252:253], v254, s[40:43], s6 offen offset:0 sc1
    s_mov_b64 exec, -1
    s_waitcnt vmcnt(0)
    s_nop 0
    s_branch PL10
    s_nop 0
PL10D:
    buffer_load_dwordx4 a[128:131], v244, s[40:43], s16 offen
    buffer_load_dwordx4 a[132:135], v245, s[40:43], s16 offen
    buffer_load_dwordx4 a[136:139], v246, s[40:43], s16 offen
    buffer_load_dwordx4 a[140:143], v247, s[40:43], s16 offen
    s_add_u32 s16, s16, 4096
    buffer_load_dwordx4 a[144:147], v244, s[40:43], s16 offen
    buffer_load_dwordx4 a[148:151], v245, s[40:43], s16 offen
    buffer_load_dwordx4 a[152:155], v246, s[40:43], s16 offen
    buffer_load_dwordx4 a[156:159], v247, s[40:43], s16 offen
    s_add_u32 s16, s16, 4096
    buffer_load_dwordx4 a[160:163], v244, s[40:43], s16 offen
    buffer_load_dwordx4 a[164:167], v245, s[40:43], s16 offen
    buffer_load_dwordx4 a[168:171], v246, s[40:43], s16 offen
    buffer_load_dwordx4 a[172:175], v247, s[40:43], s16 offen
    s_add_u32 s16, s16, 4096
    buffer_load_dwordx4 a[176:179], v244, s[40:43], s16 offen
    buffer_load_dwordx4 a[180:183], v245, s[40:43], s16 offen
    buffer_load_dwordx4 a[184:187], v246, s[40:43], s16 offen
    buffer_load_dwordx4 a[188:191], v247, s[40:43], s16 offen
    s_add_u32 s16, s16, 4096
    buffer_load_dwordx4 a[192:195], v244, s[40:43], s16 offen
    buffer_load_dwordx4 a[196:199], v245, s[40:43], s16 offen
    buffer_load_dwordx4 a[200:203], v246, s[40:43], s16 offen
    buffer_load_dwordx4 a[204:207], v247, s[40:43], s16 offen
    s_add_u32 s16, s16, 4096
    s_waitcnt vmcnt(19)
    v_mfma_f32_16x16x32_bf16 v[64:67], a[0:3], a[128:131], 0
    buffer_load_dwordx4 a[208:211], v244, s[40:43], s16 offen
    v_mfma_f32_16x16x32_bf16 v[68:71], a[4:7], a[128:131], 0
    v_mfma_f32_16x16x32_bf16 v[72:75], a[8:11], a[128:131], 0
    v_mfma_f32_16x16x32_bf16 v[76:79], a[12:15], a[128:131], 0
    s_waitcnt vmcnt(19)
    v_mfma_f32_16x16x32_bf16 v[80:83], a[0:3], a[132:135], 0
    buffer_load_dwordx4 a[212:215], v245, s[40:43], s16 offen
    v_mfma_f32_16x16x32_bf16 v[84:87], a[4:7], a[132:135], 0
    v_mfma_f32_16x16x32_bf16 v[88:91], a[8:11], a[132:135], 0
    v_mfma_f32_16x16x32_bf16 v[92:95], a[12:15], a[132:135], 0
    s_waitcnt vmcnt(19)
    v_mfma_f32_16x16x32_bf16 v[96:99], a[0:3], a[136:139], 0
    buffer_load_dwordx4 a[216:219], v246, s[40:43], s16 offen
    v_mfma_f32_16x16x32_bf16 v[100:103], a[4:7], a[136:139], 0
    v_mfma_f32_16x16x32_bf16 v[104:107], a[8:11], a[136:139], 0
    v_mfma_f32_16x16x32_bf16 v[108:111], a[12:15], a[136:139], 0
    s_waitcnt vmcnt(19)
    v_mfma_f32_16x16x32_bf16 v[112:115], a[0:3], a[140:143], 0
    buffer_load_dwordx4 a[220:223], v247, s[40:43], s16 offen
    s_add_u32 s16, s16, 4096
    v_mfma_f32_16x16x32_bf16 v[116:119], a[4:7], a[140:143], 0
    v_mfma_f32_16x16x32_bf16 v[120:123], a[8:11], a[140:143], 0
    v_mfma_f32_16x16x32_bf16 v[124:127], a[12:15], a[140:143], 0
    s_waitcnt vmcnt(19)
    v_mfma_f32_16x16x32_bf16 v[64:67], a[16:19], a[144:147], v[64:67]
    buffer_load_dwordx4 a[224:227], v244, s[40:43], s16 offen
    v_mfma_f32_16x16x32_bf16 v[68:71], a[20:23], a[144:147], v[68:71]
    v_mfma_f32_16x16x32_bf16 v[72:75], a[24:27], a[144:147], v[72:75]
    v_mfma_f32_16x16x32_bf16 v[76:79], a[28:31], a[144:147], v[76:79]
    s_waitcnt vmcnt(19)
    v_mfma_f32_16x16x32_bf16 v[80:83], a[16:19], a[148:151], v[80:83]
    buffer_load_dwordx4 a[228:231], v245, s[40:43], s16 offen
    v_mfma_f32_16x16x32_bf16 v[84:87], a[20:23], a[148:151], v[84:87]
    v_mfma_f32_16x16x32_bf16 v[88:91], a[24:27], a[148:151], v[88:91]
    v_mfma_f32_16x16x32_bf16 v[92:95], a[28:31], a[148:151], v[92:95]
    s_waitcnt vmcnt(19)
    v_mfma_f32_16x16x32_bf16 v[96:99], a[16:19], a[152:155], v[96:99]
    buffer_load_dwordx4 a[232:235], v246, s[40:43], s16 offen
    v_mfma_f32_16x16x32_bf16 v[100:103], a[20:23], a[152:155], v[100:103]
    v_mfma_f32_16x16x32_bf16 v[104:107], a[24:27], a[152:155], v[104:107]
    v_mfma_f32_16x16x32_bf16 v[108:111], a[28:31], a[152:155], v[108:111]
    s_waitcnt vmcnt(19)
    v_mfma_f32_16x16x32_bf16 v[112:115], a[16:19], a[156:159], v[112:115]
    buffer_load_dwordx4 a[236:239], v247, s[40:43], s16 offen
    s_add_u32 s16, s16, 4096
    v_mfma_f32_16x16x32_bf16 v[116:119], a[20:23], a[156:159], v[116:119]
    v_mfma_f32_16x16x32_bf16 v[120:123], a[24:27], a[156:159], v[120:123]
    v_mfma_f32_16x16x32_bf16 v[124:127], a[28:31], a[156:159], v[124:127]
    s_waitcnt vmcnt(19)
    v_mfma_f32_16x16x32_bf16 v[64:67], a[32:35], a[160:163], v[64:67]
    buffer_load_dwordx4 a[240:243], v244, s[40:43], s16 offen
    v_mfma_f32_16x16x32_bf16 v[68:71], a[36:39], a[160:163], v[68:71]
    v_mfma_f32_16x16x32_bf16 v[72:75], a[40:43], a[160:163], v[72:75]
    v_mfma_f32_16x16x32_bf16 v[76:79], a[44:47], a[160:163], v[76:79]
    s_waitcnt vmcnt(19)
    v_mfma_f32_16x16x32_bf16 v[80:83], a[32:35], a[164:167], v[80:83]
    buffer_load_dwordx4 a[244:247], v245, s[40:43], s16 offen
    v_mfma_f32_16x16x32_bf16 v[84:87], a[36:39], a[164:167], v[84:87]
    v_mfma_f32_16x16x32_bf16 v[88:91], a[40:43], a[164:167], v[88:91]
    v_mfma_f32_16x16x32_bf16 v[92:95], a[44:47], a[164:167], v[92:95]
    s_waitcnt vmcnt(19)
    v_mfma_f32_16x16x32_bf16 v[96:99], a[32:35], a[168:171], v[96:99]
    buffer_load_dwordx4 a[248:251], v246, s[40:43], s16 offen
    v_mfma_f32_16x16x32_bf16 v[100:103], a[36:39], a[168:171], v[100:103]
    v_mfma_f32_16x16x32_bf16 v[104:107], a[40:43], a[168:171], v[104:107]
    v_mfma_f32_16x16x32_bf16 v[108:111], a[44:47], a[168:171], v[108:111]
    s_waitcnt vmcnt(19)
    v_mfma_f32_16x16x32_bf16 v[112:115], a[32:35], a[172:175], v[112:115]
    buffer_load_dwordx4 a[252:255], v247, s[40:43], s16 offen
    s_add_u32 s16, s16, 4096
    v_mfma_f32_16x16x32_bf16 v[116:119], a[36:39], a[172:175], v[116:119]
    v_mfma_f32_16x16x32_bf16 v[120:123], a[40:43], a[172:175], v[120:123]
    v_mfma_f32_16x16x32_bf16 v[124:127], a[44:47], a[172:175], v[124:127]
    s_waitcnt vmcnt(19)
    v_mfma_f32_16x16x32_bf16 v[64:67], a[48:51], a[176:179], v[64:67]
    buffer_load_dwordx2 v[128:129], v240, s[40:43], s16 offen
    buffer_load_dwordx2 v[130:131], v240, s[40:43], s16 offen offset:2048
    v_mfma_f32_16x16x32_bf16 v[68:71], a[52:55], a[176:179], v[68:71]
    v_mfma_f32_16x16x32_bf16 v[72:75], a[56:59], a[176:179], v[72:75]
    v_mfma_f32_16x16x32_bf16 v[76:79], a[60:63], a[176:179], v[76:79]
    s_waitcnt vmcnt(20)
    v_mfma_f32_16x16x32_bf16 v[80:83], a[48:51], a[180:183], v[80:83]
    buffer_load_dwordx2 v[132:133], v241, s[40:43], s16 offen
    buffer_load_dwordx2 v[134:135], v241, s[40:43], s16 offen offset:2048
    v_mfma_f32_16x16x32_bf16 v[84:87], a[52:55], a[180:183], v[84:87]
    v_mfma_f32_16x16x32_bf16 v[88:91], a[56:59], a[180:183], v[88:91]
    v_mfma_f32_16x16x32_bf16 v[92:95], a[60:63], a[180:183], v[92:95]
    s_waitcnt vmcnt(21)
    v_mfma_f32_16x16x32_bf16 v[96:99], a[48:51], a[184:187], v[96:99]
    buffer_load_dwordx2 v[136:137], v242, s[40:43], s16 offen
    buffer_load_dwordx2 v[138:139], v242, s[40:43], s16 offen offset:2048
    v_mfma_f32_16x16x32_bf16 v[100:103], a[52:55], a[184:187], v[100:103]
    v_mfma_f32_16x16x32_bf16 v[104:107], a[56:59], a[184:187], v[104:107]
    v_mfma_f32_16x16x32_bf16 v[108:111], a[60:63], a[184:187], v[108:111]
    s_waitcnt vmcnt(22)
    v_mfma_f32_16x16x32_bf16 v[112:115], a[48:51], a[188:191], v[112:115]
    buffer_load_dwordx2 v[140:141], v243, s[40:43], s16 offen
    buffer_load_dwordx2 v[142:143], v243, s[40:43], s16 offen offset:2048
    s_add_u32 s16, s16, 4096
    v_mfma_f32_16x16x32_bf16 v[116:119], a[52:55], a[188:191], v[116:119]
    v_mfma_f32_16x16x32_bf16 v[120:123], a[56:59], a[188:191], v[120:123]
    v_mfma_f32_16x16x32_bf16 v[124:127], a[60:63], a[188:191], v[124:127]
    s_waitcnt vmcnt(23)
    v_mfma_f32_16x16x32_bf16 v[64:67], a[64:67], a[192:195], v[64:67]
    buffer_load_dwordx2 v[144:145], v240, s[40:43], s16 offen
    buffer_load_dwordx2 v[146:147], v240, s[40:43], s16 offen offset:2048
    v_mfma_f32_16x16x32_bf16 v[68:71], a[68:71], a[192:195], v[68:71]
    v_mfma_f32_16x16x32_bf16 v[72:75], a[72:75], a[192:195], v[72:75]
    v_mfma_f32_16x16x32_bf16 v[76:79], a[76:79], a[192:195], v[76:79]
    s_waitcnt vmcnt(24)
    v_mfma_f32_16x16x32_bf16 v[80:83], a[64:67], a[196:199], v[80:83]
    buffer_load_dwordx2 v[148:149], v241, s[40:43], s16 offen
    buffer_load_dwordx2 v[150:151], v241, s[40:43], s16 offen offset:2048
    v_mfma_f32_16x16x32_bf16 v[84:87], a[68:71], a[196:199], v[84:87]
    v_mfma_f32_16x16x32_bf16 v[88:91], a[72:75], a[196:199], v[88:91]
    v_mfma_f32_16x16x32_bf16 v[92:95], a[76:79], a[196:199], v[92:95]
    s_waitcnt vmcnt(25)
    v_mfma_f32_16x16x32_bf16 v[96:99], a[64:67], a[200:203], v[96:99]
    buffer_load_dwordx2 v[152:153], v242, s[40:43], s16 offen
    buffer_load_dwordx2 v[154:155], v242, s[40:43], s16 offen offset:2048
    v_mfma_f32_16x16x32_bf16 v[100:103], a[68:71], a[200:203], v[100:103]
    v_mfma_f32_16x16x32_bf16 v[104:107], a[72:75], a[200:203], v[104:107]
    v_mfma_f32_16x16x32_bf16 v[108:111], a[76:79], a[200:203], v[108:111]
    s_waitcnt vmcnt(26)
    v_mfma_f32_16x16x32_bf16 v[112:115], a[64:67], a[204:207], v[112:115]
    buffer_load_dwordx2 v[156:157], v243, s[40:43], s16 offen
    buffer_load_dwordx2 v[158:159], v243, s[40:43], s16 offen offset:2048
    s_add_u32 s16, s16, 4096
    v_mfma_f32_16x16x32_bf16 v[116:119], a[68:71], a[204:207], v[116:119]
    v_mfma_f32_16x16x32_bf16 v[120:123], a[72:75], a[204:207], v[120:123]
    v_mfma_f32_16x16x32_bf16 v[124:127], a[76:79], a[204:207], v[124:127]
    s_waitcnt vmcnt(27)
    v_mfma_f32_16x16x32_bf16 v[64:67], a[80:83], a[208:211], v[64:67]
    s_cmp_eq_u32 s4, 3
    s_cselect_b32 s16, 0x7ff00000, s16
    v_mfma_f32_16x16x32_bf16 v[68:71], a[84:87], a[208:211], v[68:71]
    v_mfma_f32_16x16x32_bf16 v[72:75], a[88:91], a[208:211], v[72:75]
    v_mfma_f32_16x16x32_bf16 v[76:79], a[92:95], a[208:211], v[76:79]
    s_waitcnt vmcnt(26)
    v_mfma_f32_16x16x32_bf16 v[80:83], a[80:83], a[212:215], v[80:83]
    buffer_load_dwordx2 v[160:161], v240, s[40:43], s16 offen
    buffer_load_dwordx2 v[162:163], v240, s[40:43], s16 offen offset:2048
    v_mfma_f32_16x16x32_bf16 v[84:87], a[84:87], a[212:215], v[84:87]
    v_mfma_f32_16x16x32_bf16 v[88:91], a[88:91], a[212:215], v[88:91]
    v_mfma_f32_16x16x32_bf16 v[92:95], a[92:95], a[212:215], v[92:95]
    s_waitcnt vmcnt(27)
    v_mfma_f32_16x16x32_bf16 v[96:99], a[80:83], a[216:219], v[96:99]
    buffer_load_dwordx2 v[164:165], v241, s[40:43], s16 offen
    buffer_load_dwordx2 v[166:167], v241, s[40:43], s16 offen offset:2048
    v_mfma_f32_16x16x32_bf16 v[100:103], a[84:87], a[216:219], v[100:103]
    v_mfma_f32_16x16x32_bf16 v[104:107], a[88:91], a[216:219], v[104:107]
    v_mfma_f32_16x16x32_bf16 v[108:111], a[92:95], a[216:219], v[108:111]
    s_waitcnt vmcnt(28)
    v_mfma_f32_16x16x32_bf16 v[112:115], a[80:83], a[220:223], v[112:115]
    buffer_load_dwordx2 v[168:169], v242, s[40:43], s16 offen
    buffer_load_dwordx2 v[170:171], v242, s[40:43], s16 offen offset:2048
    v_mfma_f32_16x16x32_bf16 v[116:119], a[84:87], a[220:223], v[116:119]
    v_mfma_f32_16x16x32_bf16 v[120:123], a[88:91], a[220:223], v[120:123]
    v_mfma_f32_16x16x32_bf16 v[124:127], a[92:95], a[220:223], v[124:127]
    buffer_load_dwordx2 v[172:173], v243, s[40:43], s16 offen
    buffer_load_dwordx2 v[174:175], v243, s[40:43], s16 offen offset:2048
    s_waitcnt vmcnt(31)
    v_mfma_f32_16x16x32_bf16 v[64:67], a[96:99], a[224:227], v[64:67]
    v_mfma_f32_16x16x32_bf16 v[68:71], a[100:103], a[224:227], v[68:71]
    v_mfma_f32_16x16x32_bf16 v[72:75], a[104:107], a[224:227], v[72:75]
    v_mfma_f32_16x16x32_bf16 v[76:79], a[108:111], a[224:227], v[76:79]
    s_waitcnt vmcnt(30)
    v_mfma_f32_16x16x32_bf16 v[80:83], a[96:99], a[228:231], v[80:83]
    v_mfma_f32_16x16x32_bf16 v[84:87], a[100:103], a[228:231], v[84:87]
    v_mfma_f32_16x16x32_bf16 v[88:91], a[104:107], a[228:231], v[88:91]
    v_mfma_f32_16x16x32_bf16 v[92:95], a[108:111], a[228:231], v[92:95]
    s_waitcnt vmcnt(29)
    v_mfma_f32_16x16x32_bf16 v[96:99], a[96:99], a[232:235], v[96:99]
    v_mfma_f32_16x16x32_bf16 v[100:103], a[100:103], a[232:235], v[100:103]
    v_mfma_f32_16x16x32_bf16 v[104:107], a[104:107], a[232:235], v[104:107]
    v_mfma_f32_16x16x32_bf16 v[108:111], a[108:111], a[232:235], v[108:111]
    s_waitcnt vmcnt(28)
    v_mfma_f32_16x16x32_bf16 v[112:115], a[96:99], a[236:239], v[112:115]
    v_mfma_f32_16x16x32_bf16 v[116:119], a[100:103], a[236:239], v[116:119]
    v_mfma_f32_16x16x32_bf16 v[120:123], a[104:107], a[236:239], v[120:123]
    v_mfma_f32_16x16x32_bf16 v[124:127], a[108:111], a[236:239], v[124:127]
    s_waitcnt vmcnt(27)
    v_mfma_f32_16x16x32_bf16 v[64:67], a[112:115], a[240:243], v[64:67]
    v_mfma_f32_16x16x32_bf16 v[68:71], a[116:119], a[240:243], v[68:71]
    v_mfma_f32_16x16x32_bf16 v[72:75], a[120:123], a[240:243], v[72:75]
    v_mfma_f32_16x16x32_bf16 v[76:79], a[124:127], a[240:243], v[76:79]
    s_waitcnt vmcnt(26)
    v_mfma_f32_16x16x32_bf16 v[80:83], a[112:115], a[244:247], v[80:83]
    v_mfma_f32_16x16x32_bf16 v[84:87], a[116:119], a[244:247], v[84:87]
    v_mfma_f32_16x16x32_bf16 v[88:91], a[120:123], a[244:247], v[88:91]
    v_mfma_f32_16x16x32_bf16 v[92:95], a[124:127], a[244:247], v[92:95]
    s_waitcnt vmcnt(25)
    v_mfma_f32_16x16x32_bf16 v[96:99], a[112:115], a[248:251], v[96:99]
    v_mfma_f32_16x16x32_bf16 v[100:103], a[116:119], a[248:251], v[100:103]
    v_mfma_f32_16x16x32_bf16 v[104:107], a[120:123], a[248:251], v[104:107]
    v_mfma_f32_16x16x32_bf16 v[108:111], a[124:127], a[248:251], v[108:111]
    s_waitcnt vmcnt(24)
    v_mfma_f32_16x16x32_bf16 v[112:115], a[112:115], a[252:255], v[112:115]
    v_mfma_f32_16x16x32_bf16 v[116:119], a[116:119], a[252:255], v[116:119]
    v_mfma_f32_16x16x32_bf16 v[120:123], a[120:123], a[252:255], v[120:123]
    v_mfma_f32_16x16x32_bf16 v[124:127], a[124:127], a[252:255], v[124:127]
    s_waitcnt vmcnt(22)
    v_mfma_f32_16x16x32_bf16 v[64:67], v[192:195], v[128:131], v[64:67]
    v_mfma_f32_16x16x32_bf16 v[68:71], v[196:199], v[128:131], v[68:71]
    v_mfma_f32_16x16x32_bf16 v[72:75], v[200:203], v[128:131], v[72:75]
    v_mfma_f32_16x16x32_bf16 v[76:79], v[204:207], v[128:131], v[76:79]
    s_waitcnt vmcnt(20)
    v_mfma_f32_16x16x32_bf16 v[80:83], v[192:195], v[132:135], v[80:83]
    v_mfma_f32_16x16x32_bf16 v[84:87], v[196:199], v[132:135], v[84:87]
    v_mfma_f32_16x16x32_bf16 v[88:91], v[200:203], v[132:135], v[88:91]
    v_mfma_f32_16x16x32_bf16 v[92:95], v[204:207], v[132:135], v[92:95]
    s_waitcnt vmcnt(18)
    v_mfma_f32_16x16x32_bf16 v[96:99], v[192:195], v[136:139], v[96:99]
    v_mfma_f32_16x16x32_bf16 v[100:103], v[196:199], v[136:139], v[100:103]
    v_mfma_f32_16x16x32_bf16 v[104:107], v[200:203], v[136:139], v[104:107]
    v_mfma_f32_16x16x32_bf16 v[108:111], v[204:207], v[136:139], v[108:111]
    s_waitcnt vmcnt(16)
    v_mfma_f32_16x16x32_bf16 v[112:115], v[192:195], v[140:143], v[112:115]
    v_mfma_f32_16x16x32_bf16 v[116:119], v[196:199], v[140:143], v[116:119]
    v_mfma_f32_16x16x32_bf16 v[120:123], v[200:203], v[140:143], v[120:123]
    v_mfma_f32_16x16x32_bf16 v[124:127], v[204:207], v[140:143], v[124:127]
    s_waitcnt vmcnt(14)
    v_mfma_f32_16x16x32_bf16 v[64:67], v[208:211], v[144:147], v[64:67]
    v_mfma_f32_16x16x32_bf16 v[68:71], v[212:215], v[144:147], v[68:71]
    v_mfma_f32_16x16x32_bf16 v[72:75], v[216:219], v[144:147], v[72:75]
    v_mfma_f32_16x16x32_bf16 v[76:79], v[220:223], v[144:147], v[76:79]
    s_waitcnt vmcnt(12)
    v_mfma_f32_16x16x32_bf16 v[80:83], v[208:211], v[148:151], v[80:83]
    v_mfma_f32_16x16x32_bf16 v[84:87], v[212:215], v[148:151], v[84:87]
    v_mfma_f32_16x16x32_bf16 v[88:91], v[216:219], v[148:151], v[88:91]
    v_mfma_f32_16x16x32_bf16 v[92:95], v[220:223], v[148:151], v[92:95]
    s_waitcnt vmcnt(10)
    v_mfma_f32_16x16x32_bf16 v[96:99], v[208:211], v[152:155], v[96:99]
    v_mfma_f32_16x16x32_bf16 v[100:103], v[212:215], v[152:155], v[100:103]
    v_mfma_f32_16x16x32_bf16 v[104:107], v[216:219], v[152:155], v[104:107]
    v_mfma_f32_16x16x32_bf16 v[108:111], v[220:223], v[152:155], v[108:111]
    s_waitcnt vmcnt(8)
    v_mfma_f32_16x16x32_bf16 v[112:115], v[208:211], v[156:159], v[112:115]
    v_mfma_f32_16x16x32_bf16 v[116:119], v[212:215], v[156:159], v[116:119]
    v_mfma_f32_16x16x32_bf16 v[120:123], v[216:219], v[156:159], v[120:123]
    v_mfma_f32_16x16x32_bf16 v[124:127], v[220:223], v[156:159], v[124:127]
    s_waitcnt vmcnt(6)
    v_mfma_f32_16x16x32_bf16 v[64:67], v[224:227], v[160:163], v[64:67]
    v_mfma_f32_16x16x32_bf16 v[68:71], v[228:231], v[160:163], v[68:71]
    v_mfma_f32_16x16x32_bf16 v[72:75], v[232:235], v[160:163], v[72:75]
    v_mfma_f32_16x16x32_bf16 v[76:79], v[236:239], v[160:163], v[76:79]
    s_waitcnt vmcnt(4)
    v_mfma_f32_16x16x32_bf16 v[80:83], v[224:227], v[164:167], v[80:83]
    v_mfma_f32_16x16x32_bf16 v[84:87], v[228:231], v[164:167], v[84:87]
    v_mfma_f32_16x16x32_bf16 v[88:91], v[232:235], v[164:167], v[88:91]
    v_mfma_f32_16x16x32_bf16 v[92:95], v[236:239], v[164:167], v[92:95]
    s_waitcnt vmcnt(2)
    v_mfma_f32_16x16x32_bf16 v[96:99], v[224:227], v[168:171], v[96:99]
    v_mfma_f32_16x16x32_bf16 v[100:103], v[228:231], v[168:171], v[100:103]
    v_mfma_f32_16x16x32_bf16 v[104:107], v[232:235], v[168:171], v[104:107]
    v_mfma_f32_16x16x32_bf16 v[108:111], v[236:239], v[168:171], v[108:111]
    s_waitcnt vmcnt(0)
    v_mfma_f32_16x16x32_bf16 v[112:115], v[224:227], v[172:175], v[112:115]
    v_mfma_f32_16x16x32_bf16 v[116:119], v[228:231], v[172:175], v[116:119]
    v_mfma_f32_16x16x32_bf16 v[120:123], v[232:235], v[172:175], v[120:123]
    v_mfma_f32_16x16x32_bf16 v[124:127], v[236:239], v[172:175], v[124:127]
    ds_write_b128 v249, v[80:83] offset:0
    ds_write_b128 v249, v[84:87] offset:1024
    ds_write_b128 v249, v[88:91] offset:2048
    ds_write_b128 v249, v[92:95] offset:3072
    ds_write_b128 v250, v[96:99] offset:0
    ds_write_b128 v250, v[100:103] offset:1024
    ds_write_b128 v250, v[104:107] offset:2048
    ds_write_b128 v250, v[108:111] offset:3072
    ds_write_b128 v251, v[112:115] offset:0
    ds_write_b128 v251, v[116:119] offset:1024
    ds_write_b128 v251, v[120:123] offset:2048
    ds_write_b128 v251, v[124:127] offset:3072
    s_waitcnt lgkmcnt(0)
    s_barrier
    ds_read_b128 v[128:131], v248 offset:0
    ds_read_b128 v[132:135], v248 offset:1024
    ds_read_b128 v[136:139], v248 offset:2048
    ds_read_b128 v[140:143], v248 offset:3072
    ds_read_b128 v[144:147], v248 offset:4096
    ds_read_b128 v[148:151], v248 offset:5120
    ds_read_b128 v[152:155], v248 offset:6144
    ds_read_b128 v[156:159], v248 offset:7168
    ds_read_b128 v[160:163], v248 offset:8192
    ds_read_b128 v[164:167], v248 offset:9216
    ds_read_b128 v[168:171], v248 offset:10240
    ds_read_b128 v[172:175], v248 offset:11264
    s_waitcnt lgkmcnt(11)
    v_pk_add_f32 v[64:65], v[64:65], v[128:129]
    v_pk_add_f32 v[66:67], v[66:67], v[130:131]
    s_waitcnt lgkmcnt(10)
    v_pk_add_f32 v[68:69], v[68:69], v[132:133]
    v_pk_add_f32 v[70:71], v[70:71], v[134:135]
    s_waitcnt lgkmcnt(9)
    v_pk_add_f32 v[72:73], v[72:73], v[136:137]
    v_pk_add_f32 v[74:75], v[74:75], v[138:139]
    s_waitcnt lgkmcnt(8)
    v_pk_add_f32 v[76:77], v[76:77], v[140:141]
    v_pk_add_f32 v[78:79], v[78:79], v[142:143]
    s_waitcnt lgkmcnt(7)
    v_pk_add_f32 v[64:65], v[64:65], v[144:145]
    v_pk_add_f32 v[66:67], v[66:67], v[146:147]
    s_waitcnt lgkmcnt(6)
    v_pk_add_f32 v[68:69], v[68:69], v[148:149]
    v_pk_add_f32 v[70:71], v[70:71], v[150:151]
    s_waitcnt lgkmcnt(5)
    v_pk_add_f32 v[72:73], v[72:73], v[152:153]
    v_pk_add_f32 v[74:75], v[74:75], v[154:155]
    s_waitcnt lgkmcnt(4)
    v_pk_add_f32 v[76:77], v[76:77], v[156:157]
    v_pk_add_f32 v[78:79], v[78:79], v[158:159]
    s_waitcnt lgkmcnt(3)
    v_pk_add_f32 v[64:65], v[64:65], v[160:161]
    v_pk_add_f32 v[66:67], v[66:67], v[162:163]
    s_waitcnt lgkmcnt(2)
    v_pk_add_f32 v[68:69], v[68:69], v[164:165]
    v_pk_add_f32 v[70:71], v[70:71], v[166:167]
    s_waitcnt lgkmcnt(1)
    v_pk_add_f32 v[72:73], v[72:73], v[168:169]
    v_pk_add_f32 v[74:75], v[74:75], v[170:171]
    s_waitcnt lgkmcnt(0)
    v_pk_add_f32 v[76:77], v[76:77], v[172:173]
    v_pk_add_f32 v[78:79], v[78:79], v[174:175]
    v_pk_add_f32 v[64:65], v[64:65], v[24:25]
    v_pk_add_f32 v[66:67], v[66:67], v[26:27]
    v_pk_add_f32 v[68:69], v[68:69], v[28:29]
    v_pk_add_f32 v[70:71], v[70:71], v[30:31]
    v_pk_add_f32 v[72:73], v[72:73], v[32:33]
    v_pk_add_f32 v[74:75], v[74:75], v[34:35]
    v_pk_add_f32 v[76:77], v[76:77], v[36:37]
    v_pk_add_f32 v[78:79], v[78:79], v[38:39]
    v_pk_fma_f32 v[64:65], v[64:65], v[8:9], v[48:49]
    v_pk_fma_f32 v[66:67], v[66:67], v[10:11], v[50:51]
    v_pk_fma_f32 v[68:69], v[68:69], v[12:13], v[52:53]
    v_pk_fma_f32 v[70:71], v[70:71], v[14:15], v[54:55]
    v_pk_fma_f32 v[72:73], v[72:73], v[16:17], v[56:57]
    v_pk_fma_f32 v[74:75], v[74:75], v[18:19], v[58:59]
    v_pk_fma_f32 v[76:77], v[76:77], v[20:21], v[60:61]
    v_pk_fma_f32 v[78:79], v[78:79], v[22:23], v[62:63]
    v_cvt_pk_bf16_f32 v40, v64, v65
    v_cvt_pk_bf16_f32 v41, v66, v67
    v_cvt_pk_bf16_f32 v42, v68, v69
    v_cvt_pk_bf16_f32 v43, v70, v71
    v_cvt_pk_bf16_f32 v44, v72, v73
    v_cvt_pk_bf16_f32 v45, v74, v75
    v_cvt_pk_bf16_f32 v46, v76, v77
    v_cvt_pk_bf16_f32 v47, v78, v79
    buffer_store_dwordx4 v[40:43], v1, s[44:47], s17 offen offset:0
    buffer_store_dwordx4 v[44:47], v1, s[44:47], s17 offen offset:16
    s_endpgm
    s_nop 1
MEGA_END:
    s_endpgm
.section .rodata,"a"
.p2align 6
.amdhsa_kernel adaLN_cond__ssm_conv_h3__dense_activation_squared_relu__prompt_kernel
  .amdhsa_next_free_vgpr 512
  .amdhsa_next_free_sgpr 84
  .amdhsa_accum_offset 256
  .amdhsa_group_segment_fixed_size 0
  .amdhsa_kernarg_size 128
  .amdhsa_user_sgpr_count 2
  .amdhsa_user_sgpr_kernarg_segment_ptr 1
  .amdhsa_system_sgpr_workgroup_id_x 1
  .amdhsa_float_denorm_mode_32 3
  .amdhsa_float_denorm_mode_16_64 3
.end_amdhsa_kernel
```
